```python
import torch

def _softmax(x, axis=-1):
    return torch.softmax(x, dim=axis)
def _gelu(x):
    return torch.nn.functional.gelu(x, approximate="tanh")
def _silu(x):
    return torch.nn.functional.silu(x)
def _sigmoid(x):
    return torch.sigmoid(x)
def _layernorm(x, axis=-1, eps=1e-5):
    m = x.mean(dim=axis, keepdim=True)
    v = x.var(dim=axis, keepdim=True, unbiased=False)
    return (x - m) / torch.sqrt(v + eps)
def _scatter_add(tgt, idx, src, axis=0):
    return tgt.clone().index_add_(axis, idx, src)
def _segment_sum(src, seg, n):
    out = torch.zeros((n,) + src.shape[1:], dtype=src.dtype)
    return out.index_add_(0, seg, src)
def _pad(x, pw):
    flat = tuple(v for pair in reversed(pw) for v in pair)
    return torch.nn.functional.pad(x, flat)

kernel_name = 'interleave_layers__grouped_kv_mqa__sliding_block__prompt'

def setup_inputs():

    _w = (lambda a: (lambda t: t.to(torch.bfloat16) if t.is_floating_point() else t)(torch.as_tensor(a)))
    def _A_setup():
        B, S, D, H = 1, 2048, 512, 32
        Dh = D // H
        return {
            "x": _w((lambda *s: torch.randn(*s, dtype=torch.bfloat16) * 0.05)(B, S, D)),
            "wq": _w((lambda *s: torch.randn(*s, dtype=torch.bfloat16) * 0.05)(D, H * Dh)),
            "wk": _w((lambda *s: torch.randn(*s, dtype=torch.bfloat16) * 0.05)(D, Dh)),
            "wv": _w((lambda *s: torch.randn(*s, dtype=torch.bfloat16) * 0.05)(D, Dh)),
            "wo": _w((lambda *s: torch.randn(*s, dtype=torch.bfloat16) * 0.05)(H * Dh, D)),
        }
    _A_in = _A_setup()

    def _B_setup():
        B, S, D = 1, 2048, 512
        return {
            "x": _w((lambda *s: torch.randn(*s, dtype=torch.bfloat16) * 0.05)(B, S, D)),
            "wqkv": _w((lambda *s: torch.randn(*s, dtype=torch.bfloat16) * 0.05)(D, 3 * D)),
            "wo": _w((lambda *s: torch.randn(*s, dtype=torch.bfloat16) * 0.05)(D, D)),
        }
    _B_in = _B_setup()

    return {
        "A_x": _A_in["x"],
        "A_wq": _A_in["wq"],
        "A_wk": _A_in["wk"],
        "A_wv": _A_in["wv"],
        "A_wo": _A_in["wo"],
        "B_x": _B_in["x"],
        "B_wqkv": _B_in["wqkv"],
        "B_wo": _B_in["wo"],
    }

def reference(A_x, A_wq, A_wk, A_wv, A_wo, B_x, B_wqkv, B_wo):
    def _A_ref(x, wq, wk, wv, wo):
        B, S, D = x.shape
        H = 32
        Dh = D // H
        q = (lambda x, *d: x.permute(*d))((x @ wq).reshape(B, S, H, Dh), 0, 2, 1, 3)
        k = x @ wk
        v = x @ wv
        scores = torch.einsum("bhqd,bkd->bhqk", q, k) * (Dh ** -0.5)
        p = _softmax(scores, axis=-1)
        o = torch.einsum("bhqk,bkd->bhqd", p, v)
        return (lambda x, *d: x.permute(*d))(o, 0, 2, 1, 3).reshape(B, S, H * Dh) @ wo

    def _B_ref(x, wqkv, wo):
        B, S, D = x.shape
        H = 32; Dh = D // H; W = 256
        qkv = (lambda x, *d: x.permute(*d))((x @ wqkv).reshape(B, S, 3, H, Dh), 2, 0, 3, 1, 4)
        q, k, v = qkv[0], qkv[1], qkv[2]
        scores = torch.einsum("bhqd,bhkd->bhqk", q, k) * (Dh ** -0.5)
        idx = torch.arange(S)
        mask = (idx[:, None] - idx[None, :] >= 0) & (idx[:, None] - idx[None, :] < W)
        scores = torch.where(mask[None, None], scores, -1e9)
        p = _softmax(scores, axis=-1)
        o = torch.einsum("bhqk,bhkd->bhqd", p, v)
        return (lambda x, *d: x.permute(*d))(o, 0, 2, 1, 3).reshape(B, S, D) @ wo

    x = A_x
    x = x + _A_ref(_layernorm(x, axis=-1), A_wq, A_wk, A_wv, A_wo)
    x = x + _B_ref(_layernorm(x, axis=-1), B_wqkv, B_wo)
    x = x + _A_ref(_layernorm(x, axis=-1), A_wq, A_wk, A_wv, A_wo)
    x = x + _B_ref(_layernorm(x, axis=-1), B_wqkv, B_wo)
    return x
```

```asm
; @launch grid=(256,1,1) block=(512,1,1) lds=163840
.amdgcn_target "amdgcn-amd-amdhsa--gfx950"
.text
.globl interleave_layers__grouped_kv_mqa__sliding_block__prompt_kernel
.p2align 8
.type interleave_layers__grouped_kv_mqa__sliding_block__prompt_kernel,@function
interleave_layers__grouped_kv_mqa__sliding_block__prompt_kernel:
    s_cmp_ge_u32 s2, 0x100
    s_cbranch_scc0 go
    s_endpgm
go:
    s_load_dwordx16 s[64:79], s[0:1], 0x0
    s_load_dwordx4 s[4:7], s[0:1], 0x40
    s_load_dwordx2 s[30:31], s[0:1], 0x50
    v_lshrrev_b32 v6, 6, v0
    v_and_b32 v2, 63, v0
    v_readfirstlane_b32 s22, v6
    v_lshlrev_b32 v1, 4, v2
    s_and_b32 s20, s2, 7
    s_lshl_b32 s20, s20, 2
    s_lshr_b32 s26, s2, 6
    s_add_u32 s20, s20, s26
    s_lshr_b32 s21, s2, 3
    s_and_b32 s21, s21, 7
    s_lshr_b32 s23, s22, 1
    s_and_b32 s24, s22, 1
    s_lshr_b32 s26, s22, 2
    s_lshl_b32 s26, s26, 16
    s_and_b32 s27, s22, 3
    s_lshl_b32 s28, s27, 13
    s_add_u32 s41, s26, s28
    s_lshl_b32 s26, s21, 7
    s_lshl_b32 s55, s22, 16
    s_add_u32 s55, s55, s26
    v_lshrrev_b32 v9, 3, v2
    v_and_b32 v7, 7, v2
    v_lshlrev_b32 v7, 4, v7
    v_and_b32 v8, 16, v2
    v_lshlrev_b32 v8, 1, v8
    v_xor_b32 v7, v7, v8
    v_and_b32 v216, 7, v2
    v_lshlrev_b32 v216, 4, v216
    v_lshlrev_b32 v8, 1, v8
    v_xor_b32 v216, v216, v8
    v_lshl_add_u32 v216, v9, 10, v216
    s_mul_i32 s56, s27, 0x2080
    s_lshr_b32 s57, s22, 2
    s_lshl_b32 s57, s57, 16
    s_add_u32 s56, s56, s57
    v_and_b32 v3, 15, v2
    v_lshrrev_b32 v4, 4, v2
    v_lshlrev_b32 v220, 10, v3
    v_lshl_add_u32 v220, v4, 4, v220
    s_lshl_b32 s27, s20, 16
    s_lshl_b32 s28, s23, 14
    s_add_u32 s27, s27, s28
    s_lshl_b32 s28, s24, 9
    s_add_u32 s28, s28, s27
    s_and_b32 s29, s21, 1
    s_add_u32 s54, s29, 1
    s_lshr_b32 s26, s21, 1
    s_cmp_eq_u32 s26, s23
    s_cselect_b32 s54, s54, 0
    s_waitcnt lgkmcnt(0)
    s_mov_b32 s12, s64
    s_and_b32 s13, s65, 0xffff
    s_mov_b32 s14, 0x200000
    s_mov_b32 s15, 0x00020000
    s_mov_b32 s64, s66
    s_and_b32 s65, s67, 0xffff
    s_mov_b32 s66, 0x80000
    s_mov_b32 s67, 0x00020000
    s_mov_b32 s8, s30
    s_and_b32 s9, s31, 0xffff
    s_mov_b32 s10, 0x10000000
    s_mov_b32 s11, 0x00020000
    s_lshl_b32 s26, s21, 3
    s_add_u32 s26, s26, s22
    s_cmp_eq_u32 s26, 56
    s_cbranch_scc0 nofill
    v_mov_b32 v248, -1
    v_mov_b32 v249, -1
    v_mov_b32 v250, -1
    v_mov_b32 v251, -1
    s_lshl_b32 s26, s20, 11
    buffer_store_dwordx4 v[248:251], v1, s[8:11], s26 offen offset:0 sc1
    buffer_store_dwordx4 v[248:251], v1, s[8:11], s26 offen offset:1024 sc1
    s_add_u32 s26, s26, 0x10000
    buffer_store_dwordx4 v[248:251], v1, s[8:11], s26 offen offset:0 sc1
    buffer_store_dwordx4 v[248:251], v1, s[8:11], s26 offen offset:1024 sc1
    s_add_u32 s26, s26, 0x10000
    buffer_store_dwordx4 v[248:251], v1, s[8:11], s26 offen offset:0 sc1
    buffer_store_dwordx4 v[248:251], v1, s[8:11], s26 offen offset:1024 sc1
    s_add_u32 s26, s26, 0x10000
    buffer_store_dwordx4 v[248:251], v1, s[8:11], s26 offen offset:0 sc1
    buffer_store_dwordx4 v[248:251], v1, s[8:11], s26 offen offset:1024 sc1
    s_add_u32 s26, s26, 0x10000
    s_lshl_b32 s26, s20, 9
    s_add_u32 s26, s26, 0x42000
    s_mov_b32 exec_hi, 0
    buffer_store_dwordx4 v[248:251], v1, s[8:11], s26 offen sc1
    s_lshl_b32 s26, s20, 5
    s_add_u32 s26, s26, 0x40000
    s_mov_b64 exec, 3
    buffer_store_dwordx4 v[248:251], v1, s[8:11], s26 offen sc1
    buffer_store_dwordx4 v[248:251], v1, s[8:11], s26 offen offset:1024 sc1
    s_mov_b64 exec, -1
nofill:
    s_add_u32 m0, s56, 0x0
    s_add_u32 s33, s55, 0x0
    buffer_load_dwordx4 v216, s[64:67], s33 offen lds
    s_add_u32 m0, s56, 0x418
    s_add_u32 s33, s55, 0x2000
    buffer_load_dwordx4 v216, s[64:67], s33 offen lds
    s_add_u32 m0, s56, 0x820
    s_add_u32 s33, s55, 0x4000
    buffer_load_dwordx4 v216, s[64:67], s33 offen lds
    s_add_u32 m0, s56, 0xc38
    s_add_u32 s33, s55, 0x6000
    buffer_load_dwordx4 v216, s[64:67], s33 offen lds
    s_add_u32 m0, s56, 0x1040
    s_add_u32 s33, s55, 0x8000
    buffer_load_dwordx4 v216, s[64:67], s33 offen lds
    s_add_u32 m0, s56, 0x1458
    s_add_u32 s33, s55, 0xa000
    buffer_load_dwordx4 v216, s[64:67], s33 offen lds
    s_add_u32 m0, s56, 0x1860
    s_add_u32 s33, s55, 0xc000
    buffer_load_dwordx4 v216, s[64:67], s33 offen lds
    s_add_u32 m0, s56, 0x1c78
    s_add_u32 s33, s55, 0xe000
    buffer_load_dwordx4 v216, s[64:67], s33 offen lds
    s_cmp_eq_u32 s29, 1
    s_cselect_b32 s80, s70, s68
    s_cselect_b32 s81, s71, s69
    s_and_b32 s81, s81, 0xffff
    s_mov_b32 s82, 0x4000
    s_mov_b32 s83, 0x00020000
    s_mov_b32 s16, s4
    s_and_b32 s17, s5, 0xffff
    s_mov_b32 s18, 0x200000
    s_mov_b32 s19, 0x00020000
    s_mov_b32 s84, s6
    s_and_b32 s85, s7, 0xffff
    s_mov_b32 s86, 0x100
    s_mov_b32 s87, 0x00020000
    s_lshl_b32 s26, s21, 3
    s_add_u32 s26, s26, s22
    s_cmp_eq_u32 s26, 56
    s_cbranch_scc0 noflg
    s_waitcnt vmcnt(8)
    s_lshl_b32 s26, s20, 2
    v_mov_b32 v248, 1
    s_mov_b64 exec, 1
    buffer_store_dword v248, v1, s[84:87], s26 offen offset:128 sc1
    s_mov_b64 exec, -1
noflg:
    s_cmp_eq_u32 s54, 0
    s_cbranch_scc1 nowkv
    s_lshl_b32 s32, s24, 16
    s_add_u32 m0, s32, 0x9000
    s_lshl_b32 s32, s24, 13
    s_add_u32 s32, s32, 0x0
    buffer_load_dwordx4 v1, s[80:83], s32 offen offset:0 lds
    buffer_load_dwordx4 v1, s[80:83], s32 offen offset:1024 lds
    buffer_load_dwordx4 v1, s[80:83], s32 offen offset:2048 lds
    buffer_load_dwordx4 v1, s[80:83], s32 offen offset:3072 lds
    s_lshl_b32 s32, s24, 16
    s_add_u32 m0, s32, 0xa000
    s_lshl_b32 s32, s24, 13
    s_add_u32 s32, s32, 0x1000
    buffer_load_dwordx4 v1, s[80:83], s32 offen offset:0 lds
    buffer_load_dwordx4 v1, s[80:83], s32 offen offset:1024 lds
    buffer_load_dwordx4 v1, s[80:83], s32 offen offset:2048 lds
    buffer_load_dwordx4 v1, s[80:83], s32 offen offset:3072 lds
nowkv:
    buffer_load_dwordx4 v[16:19], v220, s[12:15], s28 offen offset:0
    buffer_load_dwordx4 v[20:23], v220, s[12:15], s28 offen offset:64
    buffer_load_dwordx4 v[24:27], v220, s[12:15], s28 offen offset:128
    buffer_load_dwordx4 v[28:31], v220, s[12:15], s28 offen offset:192
    buffer_load_dwordx4 v[32:35], v220, s[12:15], s28 offen offset:256
    buffer_load_dwordx4 v[36:39], v220, s[12:15], s28 offen offset:320
    buffer_load_dwordx4 v[40:43], v220, s[12:15], s28 offen offset:384
    buffer_load_dwordx4 v[44:47], v220, s[12:15], s28 offen offset:448
    s_lshl_b32 s29, s21, 1
    s_add_u32 s29, s29, s24
    s_lshl_b32 s42, s29, 6
    s_add_u32 s42, s42, s27
    s_lshl_b32 s35, s29, 10
    buffer_load_dwordx4 v[236:239], v220, s[12:15], s42 offen
    s_and_b32 s26, s21, 4
    s_xor_b32 s26, s26, s22
    s_sub_u32 s26, s26, 4
    s_cmp_lt_u32 s26, 3
    s_cbranch_scc0 nocj
    s_lshl_b32 s94, s26, 12
    s_add_u32 s94, s94, 0xb000
    s_mul_i32 s27, s2, 3
    s_add_u32 s26, s26, s27
    s_lshr_b32 s27, s26, 7
    s_mov_b32 s96, s76
    s_mov_b32 s97, s77
    s_mov_b32 s98, 0x180000
    s_mov_b32 s28, 0xc00
    s_cmp_eq_u32 s27, 0
    s_cselect_b32 s96, s72, s96
    s_cselect_b32 s97, s73, s97
    s_cselect_b32 s98, 0x80000, s98
    s_cselect_b32 s28, 0x400, s28
    s_cmp_eq_u32 s27, 4
    s_cselect_b32 s96, s78, s96
    s_cselect_b32 s97, s79, s97
    s_cselect_b32 s98, 0x80000, s98
    s_cselect_b32 s28, 0x400, s28
    s_cmp_eq_u32 s27, 5
    s_cselect_b32 s96, s64, s96
    s_cselect_b32 s97, s65, s97
    s_cselect_b32 s98, 0x80000, s98
    s_cselect_b32 s28, 0x400, s28
    s_and_b32 s97, s97, 0xffff
    s_mov_b32 s99, 0x00020000
    s_cmp_lt_u32 s27, 3
    s_cselect_b32 s30, s27, 0
    s_lshl_b32 s30, s30, 10
    s_lshr_b32 s31, s26, 4
    s_and_b32 s31, s31, 7
    s_lshl_b32 s31, s31, 7
    s_add_u32 s30, s30, s31
    s_and_b32 s31, s26, 15
    s_lshl_b32 s31, s31, 5
    s_mul_i32 s31, s31, s28
    s_add_u32 s30, s30, s31
    v_mul_lo_u32 v218, v9, s28
    v_add_u32 v218, v218, v7
    v_xor_b32 v219, 64, v218
    s_lshl_b32 s28, s28, 3
    s_add_u32 m0, s94, 0x0
    s_nop 0
    buffer_load_dwordx4 v218, s[96:99], s30 offen lds
    s_add_u32 s30, s30, s28
    s_add_u32 m0, s94, 0x400
    s_nop 0
    buffer_load_dwordx4 v219, s[96:99], s30 offen lds
    s_add_u32 s30, s30, s28
    s_add_u32 m0, s94, 0x800
    s_nop 0
    buffer_load_dwordx4 v218, s[96:99], s30 offen lds
    s_add_u32 s30, s30, s28
    s_add_u32 m0, s94, 0xc00
    s_nop 0
    buffer_load_dwordx4 v219, s[96:99], s30 offen lds
    s_add_u32 s30, s30, s28
    s_lshl_b32 s59, s26, 8
    s_add_u32 s59, s59, 0x1000000
    s_and_b32 s100, s26, 8
    s_lshl_b32 s100, s100, 4
    s_lshl_b32 s73, s26, 12
    s_add_u32 s73, s73, 0x80000
    s_cmp_eq_u32 s27, 2
    s_cselect_b32 s74, 3, 4
    s_cselect_b32 s95, 32, 8
    s_and_b32 s26, s26, 8
    s_lshl_b32 s26, s26, 3
    s_add_u32 s94, s94, s26
nocj:
    s_mov_b32 s25, 0
    s_mov_b32 s46, 0
    s_mov_b32 s47, 0
    s_mov_b32 s43, 0
    s_mov_b32 s38, 0x0
    s_lshl_b32 s39, s21, 16
    s_lshl_b32 s26, s22, 13
    s_add_u32 s39, s39, s26
    s_add_u32 s39, s39, 0x80000
    s_and_b32 s56, s20, 3
    s_lshl_b32 s56, s56, 11
    s_add_u32 s56, s56, s39
    s_lshl_b32 s76, s21, 16
    s_lshl_b32 s26, s24, 15
    s_add_u32 s76, s76, s26
    s_add_u32 s76, s76, 0x80000
    s_mul_i32 s26, s20, 0x60000
    s_add_u32 s26, s26, 0x380000
    s_lshl_b32 s34, s22, 13
    s_add_u32 s34, s34, s26
    s_lshl_b32 s30, s23, 14
    s_add_u32 s35, s35, s30
    s_add_u32 s35, s35, s26
    s_lshl_b32 s30, s21, 2
    s_add_u32 s31, s30, s23
    s_lshl_b32 s36, s31, 9
    s_lshl_b32 s32, s24, 15
    s_add_u32 s36, s36, s32
    s_add_u32 s36, s36, s26
    s_lshl_b32 s58, s31, 12
    s_add_u32 s58, s58, 0x3c0000
    s_and_b32 s31, s22, 3
    s_add_u32 s31, s31, s30
    s_lshl_b32 s77, s31, 9
    s_lshr_b32 s32, s22, 2
    s_lshl_b32 s31, s32, 15
    s_add_u32 s77, s77, s31
    s_add_u32 s77, s77, s26
    s_lshl_b32 s31, s24, 1
    s_add_u32 s31, s31, s30
    s_lshl_b32 s37, s31, 12
    s_lshl_b32 s31, s32, 11
    s_add_u32 s37, s37, s31
    s_add_u32 s37, s37, s26
    s_add_u32 s37, s37, 0x40000
    s_lshl_b32 s53, s32, 16
    s_lshl_b32 s31, s20, 11
    s_add_u32 s53, s53, s31
    s_and_b32 s30, s21, 1
    s_lshl_b32 s31, s30, 10
    s_add_u32 s53, s53, s31
    s_lshl_b32 s30, s30, 1
    s_add_u32 s30, s30, s24
    s_lshl_b32 s78, s30, 13
    s_add_u32 s78, s78, 0x50000
    s_andn2_b32 s57, s20, 1
    s_lshl_b32 s57, s57, 11
    s_lshl_b32 s40, s20, 3
    s_add_u32 s40, s40, s21
    s_lshl_b32 s40, s40, 2
    s_add_u32 s40, s40, 0x40000
    s_cmp_eq_u32 s54, 0
    s_cselect_b32 s40, 0x7fff0000, s40
    s_cmp_eq_u32 s24, 0
    s_cselect_b32 s40, s40, 0x7fff0000
    s_mov_b32 s44, 0x0000ffff
    s_mov_b32 s45, 0x0000ffff
    s_mov_b32 s88, 0xaaaaaaaa
    s_mov_b32 s89, 0xaaaaaaaa
    s_mov_b32 s90, 0xcccccccc
    s_mov_b32 s91, 0xcccccccc
    s_mov_b32 s92, 0x00f0000f
    s_mov_b32 s93, 0xf0000f00
    s_xor_b32 s26, s22, 1
    s_lshl_b32 s75, 1, s26
    s_andn2_b32 s26, 4, s21
    s_lshl_b32 s79, 15, s26
    s_lshl_b32 s26, s20, 1
    s_add_i32 s27, s26, -8
    s_add_i32 s28, s26, 1
    s_cmp_eq_u32 s24, 0
    s_cselect_b32 s27, s27, s28
    s_ashr_i32 s28, s27, 1
    s_mul_i32 s28, s28, 0x60000
    s_and_b32 s29, s27, 1
    s_lshl_b32 s29, s29, 11
    s_add_u32 s28, s28, s29
    s_add_u32 s28, s28, s58
    s_cmp_ge_i32 s27, 0
    s_cselect_b32 s48, s28, 0x7fff0000
    s_cselect_b32 s68, -1, 0
    s_add_i32 s27, s26, -7
    s_add_i32 s28, s26, 0
    s_cmp_eq_u32 s24, 0
    s_cselect_b32 s27, s27, s28
    s_ashr_i32 s28, s27, 1
    s_mul_i32 s28, s28, 0x60000
    s_and_b32 s29, s27, 1
    s_lshl_b32 s29, s29, 11
    s_add_u32 s28, s28, s29
    s_add_u32 s28, s28, s58
    s_cmp_ge_i32 s27, 0
    s_cselect_b32 s49, s28, 0x7fff0000
    s_cselect_b32 s69, -1, 0
    s_add_i32 s27, s26, -6
    s_add_i32 s28, s26, -1
    s_cmp_eq_u32 s24, 0
    s_cselect_b32 s27, s27, s28
    s_ashr_i32 s28, s27, 1
    s_mul_i32 s28, s28, 0x60000
    s_and_b32 s29, s27, 1
    s_lshl_b32 s29, s29, 11
    s_add_u32 s28, s28, s29
    s_add_u32 s28, s28, s58
    s_cmp_ge_i32 s27, 0
    s_cselect_b32 s50, s28, 0x7fff0000
    s_cselect_b32 s70, -1, 0
    s_add_i32 s27, s26, -5
    s_add_i32 s28, s26, -2
    s_cmp_eq_u32 s24, 0
    s_cselect_b32 s27, s27, s28
    s_ashr_i32 s28, s27, 1
    s_mul_i32 s28, s28, 0x60000
    s_and_b32 s29, s27, 1
    s_lshl_b32 s29, s29, 11
    s_add_u32 s28, s28, s29
    s_add_u32 s28, s28, s58
    s_cmp_ge_i32 s27, 0
    s_cselect_b32 s51, s28, 0x7fff0000
    s_cselect_b32 s71, -1, 0
    s_add_i32 s27, s26, -4
    s_add_i32 s28, s26, -3
    s_cmp_eq_u32 s24, 0
    s_cselect_b32 s27, s27, s28
    s_ashr_i32 s28, s27, 1
    s_mul_i32 s28, s28, 0x60000
    s_and_b32 s29, s27, 1
    s_lshl_b32 s29, s29, 11
    s_add_u32 s28, s28, s29
    s_add_u32 s28, s28, s58
    s_cmp_ge_i32 s27, 0
    s_cselect_b32 s52, s28, 0x7fff0000
    s_cselect_b32 s72, -1, 0
    v_mov_b32 v232, 0x3f803f80
    v_mov_b32 v233, 0x3f803f80
    v_mov_b32 v234, 0x3f803f80
    v_mov_b32 v235, 0x3f803f80
    v_mov_b32 v12, 0xdddddddd
    s_mul_i32 s26, s22, 0x900
    s_add_u32 s26, s26, 0x20000
    v_add_u32 v10, s26, v1
    s_xor_b32 s26, s22, 1
    s_mul_i32 s26, s26, 0x900
    s_add_u32 s26, s26, 0x20000
    v_add_u32 v11, s26, v1
    s_lshl_b32 s26, s22, 10
    s_add_u32 s26, s26, 0x24800
    v_add_u32 v231, s26, v1
    s_and_b32 s26, s22, 3
    s_lshl_b32 s26, s26, 11
    s_lshr_b32 s27, s22, 2
    s_lshl_b32 s27, s27, 10
    s_add_u32 s26, s26, s27
    s_add_u32 s26, s26, 0x24800
    v_add_u32 v210, s26, v1
    s_lshl_b32 s26, s24, 16
    v_add_u32 v211, s26, v1
    v_lshlrev_b32 v6, 4, v3
    v_lshrrev_b32 v7, 5, v2
    v_and_b32 v8, 1, v4
    v_lshl_add_u32 v13, v7, 8, v6
    v_lshl_add_u32 v14, v8, 14, v13
    v_and_b32 v9, 27, v2
    v_cmp_eq_u32 vcc, 16, v9
    s_nop 1
    v_cndmask_b32 v15, 0, v232, vcc
    v_bfe_u32 v9, v2, 2, 2
    v_lshl_add_u32 v9, v4, 3, v9
    v_lshlrev_b32 v5, 7, v9
    v_bfe_u32 v9, v2, 3, 2
    v_lshl_add_u32 v5, v9, 5, v5
    v_and_b32 v9, 3, v2
    v_mul_u32_u24 v212, 0x410, v4
    v_lshl_add_u32 v212, v8, 3, v212
    v_bfe_u32 v213, v2, 2, 2
    v_lshl_add_u32 v212, v213, 7, v212
    v_lshl_add_u32 v212, v9, 4, v212
    s_lshl_b32 s26, s24, 16
    v_add_u32 v212, s26, v212
    v_bfe_u32 v213, v2, 3, 1
    v_xor_b32 v213, s24, v213
    v_xor_b32 v215, 1, v213
    v_lshl_add_u32 v214, v215, 6, v212
    v_lshl_add_u32 v212, v213, 6, v212
    v_add_u32 v213, 8, v212
    v_add_u32 v215, 8, v214
    v_lshlrev_b32 v244, s74, v9
    v_xor_b32 v244, v244, v5
    v_xor_b32 v244, s94, v244
    v_xor_b32 v245, s95, v244
    v_xor_b32 v246, 64, v244
    v_xor_b32 v247, 64, v245
    s_and_b32 s27, s23, 1
    s_lshl_b32 s28, s27, 8
    v_lshl_add_u32 v9, v8, 9, v6
    v_add_u32 v9, s28, v9
    v_lshl_add_u32 v223, v7, 12, v9
    v_lshl_add_u32 v225, v7, 11, v9
    s_lshl_b32 s29, s24, 12
    s_lshr_b32 s30, s23, 1
    s_lshl_b32 s30, s30, 10
    s_add_u32 s29, s29, s30
    s_add_u32 s29, s29, 0x24800
    v_add_u32 v225, s29, v225
    v_lshl_add_u32 v9, v7, 9, v6
    v_add_u32 v9, s28, v9
    v_and_b32 v5, 3, v2
    v_bfe_u32 v222, v2, 2, 1
    v_lshl_add_u32 v5, v222, 3, v5
    v_bfe_u32 v222, v2, 3, 1
    v_lshl_add_u32 v5, v222, 2, v5
    v_lshlrev_b32 v5, 4, v5
    v_lshl_add_u32 v5, v7, 8, v5
    s_lshl_b32 s29, s27, 9
    v_add_u32 v5, s29, v5
    v_lshl_add_u32 v224, v8, 12, v5
    v_add_u32 v224, 0x400, v224
    s_bitcmp1_b32 s21, 0
    s_cselect_b64 vcc, -1, 0
    v_cndmask_b32 v222, v9, v5, vcc
    s_lshl_b32 s29, s23, 8
    s_add_u32 s29, s29, 0x26800
    v_add_u32 v227, s29, v6
    s_lshl_b32 s30, s24, 3
    v_add_u32 v226, s30, v227
    v_lshlrev_b32 v228, 6, v4
    v_add_u32 v228, s29, v228
    s_lshl_b32 s29, s24, 7
    s_add_u32 s29, s29, 0x26c00
    v_lshl_add_u32 v229, v4, 4, s29
    v_lshl_add_u32 v230, v3, 2, s29
    v_mov_b32 v5, 0
    s_lshl_b32 s26, s22, 2
    s_add_u32 s26, s26, 0x27c00
    v_mov_b32 v6, s26
    v_lshlrev_b32 v7, 2, v2
    v_add_u32 v7, 0x27d00, v7
    v_cmp_eq_u32 vcc, 0, v2
    s_nop 1
    v_cndmask_b32 v208, v7, v6, vcc
    v_and_b32 v6, 7, v2
    v_lshlrev_b32 v6, 2, v6
    v_add_u32 v209, 0x27c00, v6
    ds_write_b32 v208, v5
    s_waitcnt lgkmcnt(0)
    s_waitcnt vmcnt(9)
    s_barrier
    s_cmp_eq_u32 s54, 0
    s_cbranch_scc1 qa_nw
    v_and_b32 v6, 31, v2
    v_lshlrev_b32 v6, 2, v6
    buffer_load_dword v253, v6, s[84:87], 0 offen offset:128 sc1
    v_bfe_u32 v6, v2, 2, 2
    v_lshlrev_b32 v6, 5, v6
    v_and_b32 v7, 3, v2
    v_lshl_add_u32 v6, v7, 3, v6
    v_lshrrev_b32 v7, 4, v2
    v_lshl_add_u32 v6, v7, 8, v6
    s_lshl_b32 s28, s24, 16
    v_add_u32 v6, s28, v6
    ds_read_b64_tr_b16 v[176:177], v6 offset:36864
    ds_read_b64_tr_b16 v[178:179], v6 offset:36992
    ds_read_b64_tr_b16 v[180:181], v6 offset:37888
    ds_read_b64_tr_b16 v[182:183], v6 offset:38016
    ds_read_b64_tr_b16 v[184:185], v6 offset:38912
    ds_read_b64_tr_b16 v[186:187], v6 offset:39040
    ds_read_b64_tr_b16 v[188:189], v6 offset:39936
    ds_read_b64_tr_b16 v[190:191], v6 offset:40064
    ds_read_b64_tr_b16 v[192:193], v6 offset:40960
    ds_read_b64_tr_b16 v[194:195], v6 offset:41088
    ds_read_b64_tr_b16 v[196:197], v6 offset:41984
    ds_read_b64_tr_b16 v[198:199], v6 offset:42112
    ds_read_b64_tr_b16 v[200:201], v6 offset:43008
    ds_read_b64_tr_b16 v[202:203], v6 offset:43136
    ds_read_b64_tr_b16 v[204:205], v6 offset:44032
    ds_read_b64_tr_b16 v[206:207], v6 offset:44160
    s_waitcnt lgkmcnt(0)
    s_add_u32 s28, s78, 0x1000
    buffer_store_dwordx4 v[176:179], v1, s[8:11], s78 offen offset:0
    buffer_store_dwordx4 v[180:183], v1, s[8:11], s78 offen offset:1024
    buffer_store_dwordx4 v[184:187], v1, s[8:11], s78 offen offset:2048
    buffer_store_dwordx4 v[188:191], v1, s[8:11], s78 offen offset:3072
    buffer_store_dwordx4 v[192:195], v1, s[8:11], s28 offen offset:0
    buffer_store_dwordx4 v[196:199], v1, s[8:11], s28 offen offset:1024
    buffer_store_dwordx4 v[200:203], v1, s[8:11], s28 offen offset:2048
    buffer_store_dwordx4 v[204:207], v1, s[8:11], s28 offen offset:3072
qa_nw:
    s_xor_b32 s28, s21, s22
    s_bitcmp1_b32 s28, 2
    s_cbranch_scc0 cs_qa
    s_bitcmp1_b32 s23, 0
    s_cselect_b64 vcc, -1, 0
    v_cndmask_b32 v6, v212, v214, vcc
    v_cndmask_b32 v7, v213, v215, vcc
    ds_read_b64_tr_b16 v[80:81], v6 offset:0
    ds_read_b64_tr_b16 v[82:83], v6 offset:512
    ds_read_b64_tr_b16 v[84:85], v7 offset:0
    ds_read_b64_tr_b16 v[86:87], v7 offset:512
    ds_read_b64_tr_b16 v[88:89], v6 offset:4160
    ds_read_b64_tr_b16 v[90:91], v6 offset:4672
    ds_read_b64_tr_b16 v[92:93], v7 offset:4160
    ds_read_b64_tr_b16 v[94:95], v7 offset:4672
    ds_read_b64_tr_b16 v[96:97], v6 offset:8320
    ds_read_b64_tr_b16 v[98:99], v6 offset:8832
    ds_read_b64_tr_b16 v[100:101], v7 offset:8320
    ds_read_b64_tr_b16 v[102:103], v7 offset:8832
    ds_read_b64_tr_b16 v[104:105], v6 offset:12480
    ds_read_b64_tr_b16 v[106:107], v6 offset:12992
    ds_read_b64_tr_b16 v[108:109], v7 offset:12480
    ds_read_b64_tr_b16 v[110:111], v7 offset:12992
    ds_read_b64_tr_b16 v[112:113], v6 offset:16640
    ds_read_b64_tr_b16 v[114:115], v6 offset:17152
    ds_read_b64_tr_b16 v[116:117], v7 offset:16640
    ds_read_b64_tr_b16 v[118:119], v7 offset:17152
    ds_read_b64_tr_b16 v[120:121], v6 offset:20800
    ds_read_b64_tr_b16 v[122:123], v6 offset:21312
    ds_read_b64_tr_b16 v[124:125], v7 offset:20800
    ds_read_b64_tr_b16 v[126:127], v7 offset:21312
    ds_read_b64_tr_b16 v[128:129], v6 offset:24960
    ds_read_b64_tr_b16 v[130:131], v6 offset:25472
    ds_read_b64_tr_b16 v[132:133], v7 offset:24960
    ds_read_b64_tr_b16 v[134:135], v7 offset:25472
    ds_read_b64_tr_b16 v[136:137], v6 offset:29120
    ds_read_b64_tr_b16 v[138:139], v6 offset:29632
    ds_read_b64_tr_b16 v[140:141], v7 offset:29120
    ds_read_b64_tr_b16 v[142:143], v7 offset:29632
    s_waitcnt lgkmcnt(14)
    v_mfma_f32_16x16x32_bf16 v[48:51], v[80:83], v[232:235], 0
    v_mfma_f32_16x16x32_bf16 v[52:55], v[84:87], v[232:235], 0
    v_mfma_f32_16x16x32_bf16 v[48:51], v[88:91], v[232:235], v[48:51]
    v_mfma_f32_16x16x32_bf16 v[52:55], v[92:95], v[232:235], v[52:55]
    v_mfma_f32_16x16x32_bf16 v[48:51], v[96:99], v[232:235], v[48:51]
    v_mfma_f32_16x16x32_bf16 v[52:55], v[100:103], v[232:235], v[52:55]
    v_mfma_f32_16x16x32_bf16 v[48:51], v[104:107], v[232:235], v[48:51]
    v_mfma_f32_16x16x32_bf16 v[52:55], v[108:111], v[232:235], v[52:55]
    s_waitcnt lgkmcnt(12)
    v_mfma_f32_16x16x32_bf16 v[48:51], v[112:115], v[232:235], v[48:51]
    v_mfma_f32_16x16x32_bf16 v[52:55], v[116:119], v[232:235], v[52:55]
    s_waitcnt lgkmcnt(8)
    v_mfma_f32_16x16x32_bf16 v[48:51], v[120:123], v[232:235], v[48:51]
    v_mfma_f32_16x16x32_bf16 v[52:55], v[124:127], v[232:235], v[52:55]
    s_waitcnt lgkmcnt(4)
    v_mfma_f32_16x16x32_bf16 v[48:51], v[128:131], v[232:235], v[48:51]
    v_mfma_f32_16x16x32_bf16 v[52:55], v[132:135], v[232:235], v[52:55]
    s_waitcnt lgkmcnt(0)
    v_mfma_f32_16x16x32_bf16 v[48:51], v[136:139], v[232:235], v[48:51]
    v_mfma_f32_16x16x32_bf16 v[52:55], v[140:143], v[232:235], v[52:55]
    s_xor_b32 s28, s23, s24
    s_and_b32 s28, s28, 1
    s_lshl_b32 s28, s28, 7
    s_lshl_b32 s29, s24, 8
    s_add_u32 s28, s28, s29
    s_add_u32 s28, s28, 0x27200
    v_and_b32 v6, 48, v2
    v_add_u32 v6, s28, v6
    ds_write_b128 v6, v[48:51]
    ds_write_b128 v6, v[52:55] offset:64
    s_waitcnt lgkmcnt(0)
cs_qa:
    v_add_u32 v5, 1, v5
    ds_write_b32 v208, v5
    s_and_b32 s26, s21, 4
    s_xor_b32 s26, s26, s22
    s_sub_u32 s26, s26, 4
    s_cmp_lt_u32 s26, 3
    s_cbranch_scc0 nocj2
    s_waitcnt vmcnt(0)
    ds_read_b64_tr_b16 v[48:49], v244 offset:0
    ds_read_b64_tr_b16 v[50:51], v244 offset:512
    ds_read_b64_tr_b16 v[52:53], v245 offset:0
    ds_read_b64_tr_b16 v[54:55], v245 offset:512
    ds_read_b64_tr_b16 v[56:57], v246 offset:0
    ds_read_b64_tr_b16 v[58:59], v246 offset:512
    ds_read_b64_tr_b16 v[60:61], v247 offset:0
    ds_read_b64_tr_b16 v[62:63], v247 offset:512
    s_waitcnt lgkmcnt(0)
    buffer_store_dwordx4 v[48:51], v1, s[8:11], s73 offen offset:0 sc1
    buffer_store_dwordx4 v[52:55], v1, s[8:11], s73 offen offset:1024 sc1
    buffer_store_dwordx4 v[56:59], v1, s[8:11], s73 offen offset:2048 sc1
    buffer_store_dwordx4 v[60:63], v1, s[8:11], s73 offen offset:3072 sc1
    v_mfma_f32_16x16x32_bf16 v[80:83], v[48:51], v[232:235], 0
    v_mfma_f32_16x16x32_bf16 v[84:87], v[52:55], v[232:235], 0
    v_mfma_f32_16x16x32_bf16 v[88:91], v[56:59], v[232:235], 0
    v_mfma_f32_16x16x32_bf16 v[92:95], v[60:63], v[232:235], 0
    v_and_b32 v6, 3, v2
    v_lshlrev_b32 v6, 6, v6
    v_xor_b32 v6, s100, v6
    v_and_b32 v7, 48, v2
    v_add_u32 v6, v6, v7
    s_nop 0
    v_cndmask_b32_e64 v80, v80, v84, s[88:89]
    s_nop 0
    v_cndmask_b32_e64 v88, v88, v92, s[88:89]
    v_cndmask_b32_e64 v248, v80, v88, s[90:91]
    v_cndmask_b32_e64 v81, v81, v85, s[88:89]
    v_cndmask_b32_e64 v89, v89, v93, s[88:89]
    v_cndmask_b32_e64 v249, v81, v89, s[90:91]
    v_cndmask_b32_e64 v82, v82, v86, s[88:89]
    v_cndmask_b32_e64 v90, v90, v94, s[88:89]
    v_cndmask_b32_e64 v250, v82, v90, s[90:91]
    v_cndmask_b32_e64 v83, v83, v87, s[88:89]
    v_cndmask_b32_e64 v91, v91, v95, s[88:89]
    v_cndmask_b32_e64 v251, v83, v91, s[90:91]
    s_mov_b32 exec_lo, 0x000f000f
    s_mov_b32 exec_hi, 0x000f000f
    buffer_store_dwordx4 v[248:251], v6, s[8:11], s59 offen sc1
    s_mov_b64 exec, -1
nocj2:
    ds_read_b64_tr_b16 v[168:169], v214 offset:0
    ds_read_b64_tr_b16 v[170:171], v214 offset:512
    ds_read_b64_tr_b16 v[172:173], v215 offset:0
    ds_read_b64_tr_b16 v[174:175], v215 offset:512
    ds_read_b64_tr_b16 v[160:161], v212 offset:0
    ds_read_b64_tr_b16 v[162:163], v212 offset:512
    ds_read_b64_tr_b16 v[164:165], v213 offset:0
    ds_read_b64_tr_b16 v[166:167], v213 offset:512
    ds_read_b64_tr_b16 v[152:153], v214 offset:4160
    ds_read_b64_tr_b16 v[154:155], v214 offset:4672
    ds_read_b64_tr_b16 v[156:157], v215 offset:4160
    ds_read_b64_tr_b16 v[158:159], v215 offset:4672
    ds_read_b64_tr_b16 v[144:145], v212 offset:4160
    ds_read_b64_tr_b16 v[146:147], v212 offset:4672
    ds_read_b64_tr_b16 v[148:149], v213 offset:4160
    ds_read_b64_tr_b16 v[150:151], v213 offset:4672
    ds_read_b64_tr_b16 v[84:85], v214 offset:8320
    ds_read_b64_tr_b16 v[86:87], v214 offset:8832
    ds_read_b64_tr_b16 v[116:117], v215 offset:8320
    ds_read_b64_tr_b16 v[118:119], v215 offset:8832
    ds_read_b64_tr_b16 v[112:113], v212 offset:8320
    ds_read_b64_tr_b16 v[114:115], v212 offset:8832
    ds_read_b64_tr_b16 v[80:81], v213 offset:8320
    ds_read_b64_tr_b16 v[82:83], v213 offset:8832
    ds_read_b64_tr_b16 v[120:121], v214 offset:12480
    ds_read_b64_tr_b16 v[122:123], v214 offset:12992
    ds_read_b64_tr_b16 v[96:97], v215 offset:12480
    ds_read_b64_tr_b16 v[98:99], v215 offset:12992
    ds_read_b64_tr_b16 v[88:89], v212 offset:12480
    ds_read_b64_tr_b16 v[90:91], v212 offset:12992
    ds_read_b64_tr_b16 v[92:93], v213 offset:12480
    ds_read_b64_tr_b16 v[94:95], v213 offset:12992
    ds_read_b64_tr_b16 v[104:105], v214 offset:16640
    ds_read_b64_tr_b16 v[106:107], v214 offset:17152
    ds_read_b64_tr_b16 v[108:109], v215 offset:16640
    ds_read_b64_tr_b16 v[110:111], v215 offset:17152
    ds_read_b64_tr_b16 v[100:101], v212 offset:16640
    ds_read_b64_tr_b16 v[102:103], v212 offset:17152
    ds_read_b64_tr_b16 v[124:125], v213 offset:16640
    ds_read_b64_tr_b16 v[126:127], v213 offset:17152
    ds_read_b64_tr_b16 v[136:137], v214 offset:20800
    ds_read_b64_tr_b16 v[138:139], v214 offset:21312
    ds_read_b64_tr_b16 v[140:141], v215 offset:20800
    ds_read_b64_tr_b16 v[142:143], v215 offset:21312
    ds_read_b64_tr_b16 v[128:129], v212 offset:20800
    ds_read_b64_tr_b16 v[130:131], v212 offset:21312
    ds_read_b64_tr_b16 v[132:133], v213 offset:20800
    ds_read_b64_tr_b16 v[134:135], v213 offset:21312
    s_cbranch_scc1 qa_pre
    s_waitcnt vmcnt(0)
    s_branch qa_pre
loop_top:
    s_barrier
    s_add_u32 s96, s34, 0x30000
    s_add_u32 s97, s96, 0x1000
    buffer_load_dwordx4 v[16:19], v1, s[8:11], s96 offen offset:0 sc1
    buffer_load_dwordx4 v[20:23], v1, s[8:11], s96 offen offset:1024 sc1
    buffer_load_dwordx4 v[24:27], v1, s[8:11], s96 offen offset:2048 sc1
    buffer_load_dwordx4 v[28:31], v1, s[8:11], s96 offen offset:3072 sc1
    buffer_load_dwordx4 v[32:35], v1, s[8:11], s97 offen offset:0 sc1
    buffer_load_dwordx4 v[36:39], v1, s[8:11], s97 offen offset:1024 sc1
    buffer_load_dwordx4 v[40:43], v1, s[8:11], s97 offen offset:2048 sc1
    buffer_load_dwordx4 v[44:47], v1, s[8:11], s97 offen offset:3072 sc1
qa_pre:
    s_lshl_b32 s28, s24, 16
    s_add_u32 s28, s28, s38
    v_add_u32 v3, s28, v1
    v_add_u32 v4, s28, v13
    s_lshl_b32 s28, s24, 12
    s_sub_u32 s28, 0x800, s28
    v_add_u32 v255, s28, v210
    s_getreg_b32 s32, hwreg(HW_REG_XCC_ID, 0, 4)
    v_mov_b32 v254, s32
    v_add_u32 v8, 0x27400, v1
    s_cmp_eq_u32 s54, 1
    s_cbranch_scc1 qa_g1
    s_cmp_eq_u32 s54, 2
    s_cbranch_scc1 qa_g2
    s_waitcnt vmcnt(7)
    v_cmp_eq_u32_e64 s[94:95], -1, v19
    s_nop 0
    s_cmp_lg_u64 s[94:95], 0
    s_cbranch_scc1 qa0_f0
qa0_o0:
    v_mfma_f32_16x16x32_bf16 v[216:219], v[16:19], v[16:19], 0
    v_mfma_f32_16x16x32_bf16 v[240:243], v[232:235], v[16:19], 0
    s_waitcnt lgkmcnt(14)
    v_mfma_f32_16x16x32_bf16 v[56:59], v[168:171], v[16:19], 0
    v_mfma_f32_16x16x32_bf16 v[60:63], v[172:175], v[16:19], 0
    s_waitcnt vmcnt(6)
    v_cmp_eq_u32_e64 s[94:95], -1, v23
    v_mfma_f32_16x16x32_bf16 v[48:51], v[160:163], v[16:19], 0
    v_mfma_f32_16x16x32_bf16 v[52:55], v[164:167], v[16:19], 0
    s_cmp_lg_u64 s[94:95], 0
    s_cbranch_scc1 qa0_f1
qa0_o1:
    v_mfma_f32_16x16x32_bf16 v[216:219], v[20:23], v[20:23], v[216:219]
    s_cmp_eq_u32 s25, 0
    s_cbranch_scc1 lr01t
    ds_read_b128 v[168:171], v211 offset:26624
    ds_read_b128 v[172:175], v211 offset:27648
    ds_read_b128 v[160:163], v211 offset:24576
    ds_read_b128 v[164:167], v211 offset:25600
lr01o:
    v_mfma_f32_16x16x32_bf16 v[240:243], v[232:235], v[20:23], v[240:243]
    v_mfma_f32_16x16x32_bf16 v[56:59], v[152:155], v[20:23], v[56:59]
    v_mfma_f32_16x16x32_bf16 v[60:63], v[156:159], v[20:23], v[60:63]
    s_waitcnt vmcnt(5)
    v_cmp_eq_u32_e64 s[94:95], -1, v27
    v_mfma_f32_16x16x32_bf16 v[48:51], v[144:147], v[20:23], v[48:51]
    v_mfma_f32_16x16x32_bf16 v[52:55], v[148:151], v[20:23], v[52:55]
    s_cmp_lg_u64 s[94:95], 0
    s_cbranch_scc1 qa0_f2
qa0_o2:
    v_mfma_f32_16x16x32_bf16 v[216:219], v[24:27], v[24:27], v[216:219]
    s_cmp_eq_u32 s25, 0
    s_cbranch_scc1 lr02t
    ds_read_b128 v[152:155], v211 offset:30720
    ds_read_b128 v[156:159], v211 offset:31744
    ds_read_b128 v[144:147], v211 offset:28672
    ds_read_b128 v[148:151], v211 offset:29696
lr02o:
    v_mfma_f32_16x16x32_bf16 v[240:243], v[232:235], v[24:27], v[240:243]
    s_waitcnt lgkmcnt(14)
    v_mfma_f32_16x16x32_bf16 v[56:59], v[84:87], v[24:27], v[56:59]
    v_mfma_f32_16x16x32_bf16 v[60:63], v[116:119], v[24:27], v[60:63]
    s_waitcnt vmcnt(4)
    v_cmp_eq_u32_e64 s[94:95], -1, v31
    v_mfma_f32_16x16x32_bf16 v[48:51], v[112:115], v[24:27], v[48:51]
    v_mfma_f32_16x16x32_bf16 v[52:55], v[80:83], v[24:27], v[52:55]
    s_cmp_lg_u64 s[94:95], 0
    s_cbranch_scc1 qa0_f3
qa0_o3:
    v_mfma_f32_16x16x32_bf16 v[216:219], v[28:31], v[28:31], v[216:219]
    v_mfma_f32_16x16x32_bf16 v[240:243], v[232:235], v[28:31], v[240:243]
    v_mfma_f32_16x16x32_bf16 v[56:59], v[120:123], v[28:31], v[56:59]
    v_mfma_f32_16x16x32_bf16 v[60:63], v[96:99], v[28:31], v[60:63]
    s_waitcnt vmcnt(3)
    v_cmp_eq_u32_e64 s[94:95], -1, v35
    v_mfma_f32_16x16x32_bf16 v[48:51], v[88:91], v[28:31], v[48:51]
    v_mfma_f32_16x16x32_bf16 v[52:55], v[92:95], v[28:31], v[52:55]
    s_cmp_lg_u64 s[94:95], 0
    s_cbranch_scc1 qa0_f4
qa0_o4:
    v_mfma_f32_16x16x32_bf16 v[216:219], v[32:35], v[32:35], v[216:219]
    v_mfma_f32_16x16x32_bf16 v[240:243], v[232:235], v[32:35], v[240:243]
    s_waitcnt lgkmcnt(12)
    v_mfma_f32_16x16x32_bf16 v[56:59], v[104:107], v[32:35], v[56:59]
    v_mfma_f32_16x16x32_bf16 v[60:63], v[108:111], v[32:35], v[60:63]
    s_waitcnt vmcnt(2)
    v_cmp_eq_u32_e64 s[94:95], -1, v39
    v_mfma_f32_16x16x32_bf16 v[48:51], v[100:103], v[32:35], v[48:51]
    v_mfma_f32_16x16x32_bf16 v[52:55], v[124:127], v[32:35], v[52:55]
    s_cmp_lg_u64 s[94:95], 0
    s_cbranch_scc1 qa0_f5
qa0_o5:
    v_mfma_f32_16x16x32_bf16 v[216:219], v[36:39], v[36:39], v[216:219]
    v_mfma_f32_16x16x32_bf16 v[240:243], v[232:235], v[36:39], v[240:243]
    s_waitcnt lgkmcnt(8)
    s_waitcnt vmcnt(1)
    v_cmp_eq_u32_e64 s[94:95], -1, v43
    v_mfma_f32_16x16x32_bf16 v[56:59], v[136:139], v[36:39], v[56:59]
    v_mfma_f32_16x16x32_bf16 v[60:63], v[140:143], v[36:39], v[60:63]
    s_cmp_lg_u64 s[94:95], 0
    s_cbranch_scc1 qa0_f6
qa0_o6:
    v_mfma_f32_16x16x32_bf16 v[216:219], v[40:43], v[40:43], v[216:219]
    v_mfma_f32_16x16x32_bf16 v[240:243], v[232:235], v[40:43], v[240:243]
    s_waitcnt lgkmcnt(4)
    s_waitcnt vmcnt(0)
    v_cmp_eq_u32_e64 s[94:95], -1, v47
    v_mfma_f32_16x16x32_bf16 v[56:59], v[168:171], v[40:43], v[56:59]
    v_mfma_f32_16x16x32_bf16 v[60:63], v[172:175], v[40:43], v[60:63]
    s_cmp_lg_u64 s[94:95], 0
    s_cbranch_scc1 qa0_f7
qa0_o7:
    v_mfma_f32_16x16x32_bf16 v[216:219], v[44:47], v[44:47], v[216:219]
    v_mfma_f32_16x16x32_bf16 v[240:243], v[232:235], v[44:47], v[240:243]
    s_waitcnt lgkmcnt(0)
    v_mfma_f32_16x16x32_bf16 v[56:59], v[152:155], v[44:47], v[56:59]
    v_mfma_f32_16x16x32_bf16 v[60:63], v[156:159], v[44:47], v[60:63]
    v_add_u32 v5, 1, v5
    s_nop 2
    v_cndmask_b32_e64 v6, v216, v217, s[88:89]
    v_cndmask_b32_e64 v7, v218, v219, s[88:89]
    v_cndmask_b32_e64 v241, v6, v7, s[90:91]
    s_mov_b64 exec, s[92:93]
    ds_write_b64 v226, v[240:241]
    s_mov_b64 exec, -1
    s_branch qa_gx
qa_g1:
    s_setprio 2
    s_waitcnt vmcnt(8)
    v_mfma_f32_16x16x32_bf16 v[68:71], v[176:179], v[232:235], 0
    v_mfma_f32_16x16x32_bf16 v[68:71], v[180:183], v[232:235], v[68:71]
    v_mfma_f32_16x16x32_bf16 v[68:71], v[184:187], v[232:235], v[68:71]
    v_mfma_f32_16x16x32_bf16 v[68:71], v[188:191], v[232:235], v[68:71]
    v_mfma_f32_16x16x32_bf16 v[68:71], v[192:195], v[232:235], v[68:71]
    v_mfma_f32_16x16x32_bf16 v[68:71], v[196:199], v[232:235], v[68:71]
    v_mfma_f32_16x16x32_bf16 v[68:71], v[200:203], v[232:235], v[68:71]
    v_mfma_f32_16x16x32_bf16 v[68:71], v[204:207], v[232:235], v[68:71]
    s_waitcnt vmcnt(7)
    v_cmp_eq_u32_e64 s[94:95], -1, v19
    s_nop 0
    s_cmp_lg_u64 s[94:95], 0
    s_cbranch_scc1 qa1_f0
qa1_o0:
    v_mfma_f32_16x16x32_bf16 v[64:67], v[176:179], v[16:19], 0
    v_mfma_f32_16x16x32_bf16 v[216:219], v[16:19], v[16:19], 0
    v_mfma_f32_16x16x32_bf16 v[240:243], v[232:235], v[16:19], 0
    s_waitcnt lgkmcnt(14)
    v_mfma_f32_16x16x32_bf16 v[56:59], v[168:171], v[16:19], 0
    v_mfma_f32_16x16x32_bf16 v[60:63], v[172:175], v[16:19], 0
    s_waitcnt vmcnt(6)
    v_cmp_eq_u32_e64 s[94:95], -1, v23
    v_mfma_f32_16x16x32_bf16 v[48:51], v[160:163], v[16:19], 0
    v_mfma_f32_16x16x32_bf16 v[52:55], v[164:167], v[16:19], 0
    s_cmp_lg_u64 s[94:95], 0
    s_cbranch_scc1 qa1_f1
qa1_o1:
    v_mfma_f32_16x16x32_bf16 v[64:67], v[180:183], v[20:23], v[64:67]
    s_cmp_eq_u32 s25, 0
    s_cbranch_scc1 lr11t
    ds_read_b128 v[168:171], v211 offset:26624
    ds_read_b128 v[172:175], v211 offset:27648
    ds_read_b128 v[160:163], v211 offset:24576
    ds_read_b128 v[164:167], v211 offset:25600
lr11o:
    v_mfma_f32_16x16x32_bf16 v[216:219], v[20:23], v[20:23], v[216:219]
    v_mfma_f32_16x16x32_bf16 v[240:243], v[232:235], v[20:23], v[240:243]
    v_mfma_f32_16x16x32_bf16 v[56:59], v[152:155], v[20:23], v[56:59]
    v_mfma_f32_16x16x32_bf16 v[60:63], v[156:159], v[20:23], v[60:63]
    s_waitcnt vmcnt(5)
    v_cmp_eq_u32_e64 s[94:95], -1, v27
    v_mfma_f32_16x16x32_bf16 v[48:51], v[144:147], v[20:23], v[48:51]
    v_mfma_f32_16x16x32_bf16 v[52:55], v[148:151], v[20:23], v[52:55]
    s_cmp_lg_u64 s[94:95], 0
    s_cbranch_scc1 qa1_f2
qa1_o2:
    v_mfma_f32_16x16x32_bf16 v[64:67], v[184:187], v[24:27], v[64:67]
    s_cmp_eq_u32 s25, 0
    s_cbranch_scc1 lr12t
    ds_read_b128 v[152:155], v211 offset:30720
    ds_read_b128 v[156:159], v211 offset:31744
    ds_read_b128 v[144:147], v211 offset:28672
    ds_read_b128 v[148:151], v211 offset:29696
lr12o:
    s_waitcnt vmcnt(4)
    v_cmp_eq_u32_e64 s[94:95], -1, v31
    v_mfma_f32_16x16x32_bf16 v[216:219], v[24:27], v[24:27], v[216:219]
    v_mfma_f32_16x16x32_bf16 v[240:243], v[232:235], v[24:27], v[240:243]
    s_cmp_lg_u64 s[94:95], 0
    s_cbranch_scc1 qa1_f3
qa1_o3:
    v_mfma_f32_16x16x32_bf16 v[64:67], v[188:191], v[28:31], v[64:67]
    s_waitcnt vmcnt(3)
    v_cmp_eq_u32_e64 s[94:95], -1, v35
    v_mfma_f32_16x16x32_bf16 v[216:219], v[28:31], v[28:31], v[216:219]
    v_mfma_f32_16x16x32_bf16 v[240:243], v[232:235], v[28:31], v[240:243]
    s_cmp_lg_u64 s[94:95], 0
    s_cbranch_scc1 qa1_f4
qa1_o4:
    v_mfma_f32_16x16x32_bf16 v[64:67], v[192:195], v[32:35], v[64:67]
    s_waitcnt vmcnt(2)
    v_cmp_eq_u32_e64 s[94:95], -1, v39
    v_mfma_f32_16x16x32_bf16 v[216:219], v[32:35], v[32:35], v[216:219]
    v_mfma_f32_16x16x32_bf16 v[240:243], v[232:235], v[32:35], v[240:243]
    s_cmp_lg_u64 s[94:95], 0
    s_cbranch_scc1 qa1_f5
qa1_o5:
    v_mfma_f32_16x16x32_bf16 v[64:67], v[196:199], v[36:39], v[64:67]
    s_waitcnt vmcnt(1)
    v_cmp_eq_u32_e64 s[94:95], -1, v43
    v_mfma_f32_16x16x32_bf16 v[216:219], v[36:39], v[36:39], v[216:219]
    v_mfma_f32_16x16x32_bf16 v[240:243], v[232:235], v[36:39], v[240:243]
    s_cmp_lg_u64 s[94:95], 0
    s_cbranch_scc1 qa1_f6
qa1_o6:
    v_mfma_f32_16x16x32_bf16 v[64:67], v[200:203], v[40:43], v[64:67]
    s_waitcnt vmcnt(0)
    v_cmp_eq_u32_e64 s[94:95], -1, v47
    v_mfma_f32_16x16x32_bf16 v[216:219], v[40:43], v[40:43], v[216:219]
    v_mfma_f32_16x16x32_bf16 v[240:243], v[232:235], v[40:43], v[240:243]
    s_cmp_lg_u64 s[94:95], 0
    s_cbranch_scc1 qa1_f7
qa1_o7:
    v_mfma_f32_16x16x32_bf16 v[64:67], v[204:207], v[44:47], v[64:67]
    v_mfma_f32_16x16x32_bf16 v[216:219], v[44:47], v[44:47], v[216:219]
    v_mfma_f32_16x16x32_bf16 v[240:243], v[232:235], v[44:47], v[240:243]
    s_waitcnt lgkmcnt(14)
    v_mfma_f32_16x16x32_bf16 v[56:59], v[84:87], v[24:27], v[56:59]
    v_mfma_f32_16x16x32_bf16 v[60:63], v[116:119], v[24:27], v[60:63]
    v_mfma_f32_16x16x32_bf16 v[48:51], v[112:115], v[24:27], v[48:51]
    v_mfma_f32_16x16x32_bf16 v[52:55], v[80:83], v[24:27], v[52:55]
    s_nop 1
    v_cndmask_b32_e64 v6, v216, v217, s[88:89]
    v_cndmask_b32_e64 v7, v218, v219, s[88:89]
    v_cndmask_b32_e64 v241, v6, v7, s[90:91]
    s_mov_b64 exec, s[92:93]
    ds_write_b64 v226, v[240:241]
    s_mov_b64 exec, -1
    s_cmp_eq_u32 s24, 0
    s_cbranch_scc1 qa_fin1
    ds_write_b128 v8, v[64:67]
    ds_write_b128 v8, v[68:71] offset:1024
    v_add_u32 v5, 1, v5
    ds_write_b32 v208, v5
    s_waitcnt lgkmcnt(0)
    s_branch qa_rest1
qa_fin1:
    v_add_u32 v5, 1, v5
    ds_write_b32 v208, v5
    s_cmp_lg_u32 s25, 0
    s_cbranch_scc1 init_ok1
    v_and_b32 v6, 31, v2
    v_lshlrev_b32 v6, 2, v6
init_poll1:
    v_cmp_eq_u32 vcc, 0, v253
    s_nop 0
    s_cbranch_vccz init_ok1
    s_cmp_lg_u32 s46, 0
    s_cbranch_scc1 init_ok1
    s_add_u32 s47, s47, 1
    s_cmp_ge_u32 s47, 0xf4240
    s_cselect_b32 s46, 1, 0
    s_sleep 1
    buffer_load_dword v253, v6, s[84:87], 0 offen offset:128 sc1
    s_waitcnt vmcnt(0)
    s_branch init_poll1
init_ok1:
    ds_read_b32 v221, v209
    ds_read_b128 v[176:179], v8
    ds_read_b128 v[180:183], v8 offset:1024
    ds_read_b128 v[184:187], v227
    s_waitcnt lgkmcnt(3)
pw_1:
    v_cmp_lt_u32 vcc, v221, v5
    s_nop 0
    s_and_b32 s30, vcc_lo, s75
    s_cbranch_scc1 pw_1f
pw_1o:
    s_add_u32 s28, s53, s38
    s_waitcnt lgkmcnt(0)
    v_pk_add_f32 v[64:65], v[64:65], v[176:177]
    v_pk_add_f32 v[68:69], v[68:69], v[180:181]
    v_pk_add_f32 v[66:67], v[66:67], v[178:179]
    v_pk_add_f32 v[70:71], v[70:71], v[182:183]
    v_pk_add_f32 v[184:185], v[184:185], v[186:187]
    v_mul_f32 v184, 0xbb000000, v184
    v_mul_f32 v185, 0x3b000000, v185
    v_fma_f32 v185, -v184, v184, v185
    v_max_f32 v185, 0, v185
    v_add_f32 v185, 0x3727c5ac, v185
    v_rsq_f32 v204, v185
    s_nop 0
    v_mul_f32 v200, v184, v204
    v_mul_f32 v64, v204, v64
    v_mul_f32 v65, v204, v65
    v_mul_f32 v66, v204, v66
    v_mul_f32 v67, v204, v67
    v_fmac_f32 v64, v200, v68
    v_fmac_f32 v65, v200, v69
    v_fmac_f32 v66, v200, v70
    v_fmac_f32 v67, v200, v71
    v_cvt_pk_bf16_f32 v176, v64, v65
    v_cvt_pk_bf16_f32 v178, v64, v65
    v_cvt_pk_bf16_f32 v177, v66, v67
    v_cvt_pk_bf16_f32 v179, v66, v67
    v_permlane16_swap_b32 v176, v178
    s_nop 0
    v_permlane16_swap_b32 v177, v179
    s_mov_b64 exec, s[44:45]
    buffer_store_dwordx4 v[176:179], v222, s[8:11], s28 offen sc1
    s_mov_b64 exec, -1
qa_rest1:
    v_mfma_f32_16x16x32_bf16 v[56:59], v[120:123], v[28:31], v[56:59]
    v_mfma_f32_16x16x32_bf16 v[60:63], v[96:99], v[28:31], v[60:63]
    v_mfma_f32_16x16x32_bf16 v[48:51], v[88:91], v[28:31], v[48:51]
    v_mfma_f32_16x16x32_bf16 v[52:55], v[92:95], v[28:31], v[52:55]
    v_mfma_f32_16x16x32_bf16 v[56:59], v[104:107], v[32:35], v[56:59]
    v_mfma_f32_16x16x32_bf16 v[60:63], v[108:111], v[32:35], v[60:63]
    v_mfma_f32_16x16x32_bf16 v[48:51], v[100:103], v[32:35], v[48:51]
    v_mfma_f32_16x16x32_bf16 v[52:55], v[124:127], v[32:35], v[52:55]
    v_mfma_f32_16x16x32_bf16 v[56:59], v[136:139], v[36:39], v[56:59]
    v_mfma_f32_16x16x32_bf16 v[60:63], v[140:143], v[36:39], v[60:63]
    v_mfma_f32_16x16x32_bf16 v[56:59], v[168:171], v[40:43], v[56:59]
    v_mfma_f32_16x16x32_bf16 v[60:63], v[172:175], v[40:43], v[60:63]
    v_mfma_f32_16x16x32_bf16 v[56:59], v[152:155], v[44:47], v[56:59]
    v_mfma_f32_16x16x32_bf16 v[60:63], v[156:159], v[44:47], v[60:63]
    s_setprio 0
    s_branch qa_gx
qa_g2:
    s_setprio 2
    s_waitcnt vmcnt(8)
    v_mfma_f32_16x16x32_bf16 v[68:71], v[232:235], v[176:179], 0
    v_mfma_f32_16x16x32_bf16 v[68:71], v[232:235], v[180:183], v[68:71]
    v_mfma_f32_16x16x32_bf16 v[68:71], v[232:235], v[184:187], v[68:71]
    v_mfma_f32_16x16x32_bf16 v[68:71], v[232:235], v[188:191], v[68:71]
    v_mfma_f32_16x16x32_bf16 v[68:71], v[232:235], v[192:195], v[68:71]
    v_mfma_f32_16x16x32_bf16 v[68:71], v[232:235], v[196:199], v[68:71]
    v_mfma_f32_16x16x32_bf16 v[68:71], v[232:235], v[200:203], v[68:71]
    v_mfma_f32_16x16x32_bf16 v[68:71], v[232:235], v[204:207], v[68:71]
    s_waitcnt vmcnt(7)
    v_cmp_eq_u32_e64 s[94:95], -1, v19
    s_nop 0
    s_cmp_lg_u64 s[94:95], 0
    s_cbranch_scc1 qa2_f0
qa2_o0:
    v_mfma_f32_16x16x32_bf16 v[64:67], v[16:19], v[176:179], 0
    v_mfma_f32_16x16x32_bf16 v[216:219], v[16:19], v[16:19], 0
    v_mfma_f32_16x16x32_bf16 v[240:243], v[232:235], v[16:19], 0
    s_waitcnt lgkmcnt(14)
    v_mfma_f32_16x16x32_bf16 v[56:59], v[168:171], v[16:19], 0
    v_mfma_f32_16x16x32_bf16 v[60:63], v[172:175], v[16:19], 0
    s_waitcnt vmcnt(6)
    v_cmp_eq_u32_e64 s[94:95], -1, v23
    v_mfma_f32_16x16x32_bf16 v[48:51], v[160:163], v[16:19], 0
    v_mfma_f32_16x16x32_bf16 v[52:55], v[164:167], v[16:19], 0
    s_cmp_lg_u64 s[94:95], 0
    s_cbranch_scc1 qa2_f1
qa2_o1:
    v_mfma_f32_16x16x32_bf16 v[64:67], v[20:23], v[180:183], v[64:67]
    s_cmp_eq_u32 s25, 0
    s_cbranch_scc1 lr21t
    ds_read_b128 v[168:171], v211 offset:26624
    ds_read_b128 v[172:175], v211 offset:27648
    ds_read_b128 v[160:163], v211 offset:24576
    ds_read_b128 v[164:167], v211 offset:25600
lr21o:
    v_mfma_f32_16x16x32_bf16 v[216:219], v[20:23], v[20:23], v[216:219]
    v_mfma_f32_16x16x32_bf16 v[240:243], v[232:235], v[20:23], v[240:243]
    v_mfma_f32_16x16x32_bf16 v[56:59], v[152:155], v[20:23], v[56:59]
    v_mfma_f32_16x16x32_bf16 v[60:63], v[156:159], v[20:23], v[60:63]
    s_waitcnt vmcnt(5)
    v_cmp_eq_u32_e64 s[94:95], -1, v27
    v_mfma_f32_16x16x32_bf16 v[48:51], v[144:147], v[20:23], v[48:51]
    v_mfma_f32_16x16x32_bf16 v[52:55], v[148:151], v[20:23], v[52:55]
    s_cmp_lg_u64 s[94:95], 0
    s_cbranch_scc1 qa2_f2
qa2_o2:
    v_mfma_f32_16x16x32_bf16 v[64:67], v[24:27], v[184:187], v[64:67]
    s_cmp_eq_u32 s25, 0
    s_cbranch_scc1 lr22t
    ds_read_b128 v[152:155], v211 offset:30720
    ds_read_b128 v[156:159], v211 offset:31744
    ds_read_b128 v[144:147], v211 offset:28672
    ds_read_b128 v[148:151], v211 offset:29696
lr22o:
    s_waitcnt vmcnt(4)
    v_cmp_eq_u32_e64 s[94:95], -1, v31
    v_mfma_f32_16x16x32_bf16 v[216:219], v[24:27], v[24:27], v[216:219]
    v_mfma_f32_16x16x32_bf16 v[240:243], v[232:235], v[24:27], v[240:243]
    s_cmp_lg_u64 s[94:95], 0
    s_cbranch_scc1 qa2_f3
qa2_o3:
    v_mfma_f32_16x16x32_bf16 v[64:67], v[28:31], v[188:191], v[64:67]
    s_waitcnt vmcnt(3)
    v_cmp_eq_u32_e64 s[94:95], -1, v35
    v_mfma_f32_16x16x32_bf16 v[216:219], v[28:31], v[28:31], v[216:219]
    v_mfma_f32_16x16x32_bf16 v[240:243], v[232:235], v[28:31], v[240:243]
    s_cmp_lg_u64 s[94:95], 0
    s_cbranch_scc1 qa2_f4
qa2_o4:
    v_mfma_f32_16x16x32_bf16 v[64:67], v[32:35], v[192:195], v[64:67]
    s_waitcnt vmcnt(2)
    v_cmp_eq_u32_e64 s[94:95], -1, v39
    v_mfma_f32_16x16x32_bf16 v[216:219], v[32:35], v[32:35], v[216:219]
    v_mfma_f32_16x16x32_bf16 v[240:243], v[232:235], v[32:35], v[240:243]
    s_cmp_lg_u64 s[94:95], 0
    s_cbranch_scc1 qa2_f5
qa2_o5:
    v_mfma_f32_16x16x32_bf16 v[64:67], v[36:39], v[196:199], v[64:67]
    s_waitcnt vmcnt(1)
    v_cmp_eq_u32_e64 s[94:95], -1, v43
    v_mfma_f32_16x16x32_bf16 v[216:219], v[36:39], v[36:39], v[216:219]
    v_mfma_f32_16x16x32_bf16 v[240:243], v[232:235], v[36:39], v[240:243]
    s_cmp_lg_u64 s[94:95], 0
    s_cbranch_scc1 qa2_f6
qa2_o6:
    v_mfma_f32_16x16x32_bf16 v[64:67], v[40:43], v[200:203], v[64:67]
    s_waitcnt vmcnt(0)
    v_cmp_eq_u32_e64 s[94:95], -1, v47
    v_mfma_f32_16x16x32_bf16 v[216:219], v[40:43], v[40:43], v[216:219]
    v_mfma_f32_16x16x32_bf16 v[240:243], v[232:235], v[40:43], v[240:243]
    s_cmp_lg_u64 s[94:95], 0
    s_cbranch_scc1 qa2_f7
qa2_o7:
    v_mfma_f32_16x16x32_bf16 v[64:67], v[44:47], v[204:207], v[64:67]
    v_mfma_f32_16x16x32_bf16 v[216:219], v[44:47], v[44:47], v[216:219]
    v_mfma_f32_16x16x32_bf16 v[240:243], v[232:235], v[44:47], v[240:243]
    s_waitcnt lgkmcnt(14)
    v_mfma_f32_16x16x32_bf16 v[56:59], v[84:87], v[24:27], v[56:59]
    v_mfma_f32_16x16x32_bf16 v[60:63], v[116:119], v[24:27], v[60:63]
    v_mfma_f32_16x16x32_bf16 v[48:51], v[112:115], v[24:27], v[48:51]
    v_mfma_f32_16x16x32_bf16 v[52:55], v[80:83], v[24:27], v[52:55]
    s_nop 1
    v_cndmask_b32_e64 v6, v216, v217, s[88:89]
    v_cndmask_b32_e64 v7, v218, v219, s[88:89]
    v_cndmask_b32_e64 v241, v6, v7, s[90:91]
    s_mov_b64 exec, s[92:93]
    ds_write_b64 v226, v[240:241]
    s_mov_b64 exec, -1
    s_cmp_eq_u32 s24, 0
    s_cbranch_scc1 qa_fin2
    ds_write_b128 v8, v[64:67]
    ds_write_b128 v8, v[68:71] offset:1024
    v_add_u32 v5, 1, v5
    ds_write_b32 v208, v5
    s_waitcnt lgkmcnt(0)
    s_branch qa_rest2
qa_fin2:
    v_add_u32 v5, 1, v5
    ds_write_b32 v208, v5
    s_cmp_lg_u32 s25, 0
    s_cbranch_scc1 init_ok2
    v_and_b32 v6, 31, v2
    v_lshlrev_b32 v6, 2, v6
init_poll2:
    v_cmp_eq_u32 vcc, 0, v253
    s_nop 0
    s_cbranch_vccz init_ok2
    s_cmp_lg_u32 s46, 0
    s_cbranch_scc1 init_ok2
    s_add_u32 s47, s47, 1
    s_cmp_ge_u32 s47, 0xf4240
    s_cselect_b32 s46, 1, 0
    s_sleep 1
    buffer_load_dword v253, v6, s[84:87], 0 offen offset:128 sc1
    s_waitcnt vmcnt(0)
    s_branch init_poll2
init_ok2:
    ds_read_b32 v221, v209
    ds_read_b128 v[176:179], v8
    ds_read_b128 v[180:183], v8 offset:1024
    ds_read_b128 v[184:187], v228 offset:0
    ds_read_b128 v[188:191], v228 offset:16
    ds_read_b128 v[192:195], v228 offset:32
    ds_read_b128 v[196:199], v228 offset:48
    s_waitcnt lgkmcnt(6)
pw_2:
    v_cmp_lt_u32 vcc, v221, v5
    s_nop 0
    s_and_b32 s30, vcc_lo, s75
    s_cbranch_scc1 pw_2f
pw_2o:
    s_add_u32 s28, s53, s38
    s_waitcnt lgkmcnt(0)
    v_pk_add_f32 v[64:65], v[64:65], v[176:177]
    v_pk_add_f32 v[68:69], v[68:69], v[180:181]
    v_pk_add_f32 v[66:67], v[66:67], v[178:179]
    v_pk_add_f32 v[70:71], v[70:71], v[182:183]
    v_pk_add_f32 v[184:185], v[184:185], v[186:187]
    v_pk_add_f32 v[188:189], v[188:189], v[190:191]
    v_pk_add_f32 v[192:193], v[192:193], v[194:195]
    v_pk_add_f32 v[196:197], v[196:197], v[198:199]
    v_mul_f32 v184, 0xbb000000, v184
    v_mul_f32 v188, 0xbb000000, v188
    v_mul_f32 v192, 0xbb000000, v192
    v_mul_f32 v196, 0xbb000000, v196
    v_mul_f32 v185, 0x3b000000, v185
    v_mul_f32 v189, 0x3b000000, v189
    v_mul_f32 v193, 0x3b000000, v193
    v_mul_f32 v197, 0x3b000000, v197
    v_fma_f32 v185, -v184, v184, v185
    v_fma_f32 v189, -v188, v188, v189
    v_fma_f32 v193, -v192, v192, v193
    v_fma_f32 v197, -v196, v196, v197
    v_max_f32 v185, 0, v185
    v_max_f32 v189, 0, v189
    v_max_f32 v193, 0, v193
    v_max_f32 v197, 0, v197
    v_add_f32 v185, 0x3727c5ac, v185
    v_add_f32 v189, 0x3727c5ac, v189
    v_add_f32 v193, 0x3727c5ac, v193
    v_add_f32 v197, 0x3727c5ac, v197
    v_rsq_f32 v204, v185
    v_rsq_f32 v205, v189
    v_rsq_f32 v206, v193
    v_rsq_f32 v207, v197
    v_mul_f32 v200, v184, v204
    v_mul_f32 v201, v188, v205
    v_mul_f32 v202, v192, v206
    v_mul_f32 v203, v196, v207
    v_pk_mul_f32 v[64:65], v[64:65], v[204:205]
    v_pk_fma_f32 v[64:65], v[68:69], v[200:201], v[64:65]
    v_pk_mul_f32 v[66:67], v[66:67], v[206:207]
    v_pk_fma_f32 v[66:67], v[70:71], v[202:203], v[66:67]
    v_cvt_pk_bf16_f32 v176, v64, v65
    v_cvt_pk_bf16_f32 v178, v64, v65
    v_cvt_pk_bf16_f32 v177, v66, v67
    v_cvt_pk_bf16_f32 v179, v66, v67
    v_permlane16_swap_b32 v176, v178
    s_nop 0
    v_permlane16_swap_b32 v177, v179
    s_mov_b64 exec, s[44:45]
    buffer_store_dwordx4 v[176:179], v222, s[8:11], s28 offen sc1
    s_mov_b64 exec, -1
qa_rest2:
    v_mfma_f32_16x16x32_bf16 v[56:59], v[120:123], v[28:31], v[56:59]
    v_mfma_f32_16x16x32_bf16 v[60:63], v[96:99], v[28:31], v[60:63]
    v_mfma_f32_16x16x32_bf16 v[48:51], v[88:91], v[28:31], v[48:51]
    v_mfma_f32_16x16x32_bf16 v[52:55], v[92:95], v[28:31], v[52:55]
    v_mfma_f32_16x16x32_bf16 v[56:59], v[104:107], v[32:35], v[56:59]
    v_mfma_f32_16x16x32_bf16 v[60:63], v[108:111], v[32:35], v[60:63]
    v_mfma_f32_16x16x32_bf16 v[48:51], v[100:103], v[32:35], v[48:51]
    v_mfma_f32_16x16x32_bf16 v[52:55], v[124:127], v[32:35], v[52:55]
    v_mfma_f32_16x16x32_bf16 v[56:59], v[136:139], v[36:39], v[56:59]
    v_mfma_f32_16x16x32_bf16 v[60:63], v[140:143], v[36:39], v[60:63]
    v_mfma_f32_16x16x32_bf16 v[56:59], v[168:171], v[40:43], v[56:59]
    v_mfma_f32_16x16x32_bf16 v[60:63], v[172:175], v[40:43], v[60:63]
    v_mfma_f32_16x16x32_bf16 v[56:59], v[152:155], v[44:47], v[56:59]
    v_mfma_f32_16x16x32_bf16 v[60:63], v[156:159], v[44:47], v[60:63]
    s_setprio 0
qa_gx:
    v_mov_b32 v80, v15
    v_mov_b32 v81, v15
    v_mov_b64 v[82:83], v[80:81]
    v_mov_b64 v[84:85], v[80:81]
    v_mov_b64 v[86:87], v[80:81]
    v_mov_b64 v[88:89], v[80:81]
    v_mov_b64 v[90:91], v[80:81]
    v_mov_b64 v[92:93], v[80:81]
    ds_write_b128 v10, v[56:59]
    ds_write_b128 v10, v[60:63] offset:1024
    v_add_u32 v5, 1, v5
    ds_write_b32 v208, v5
    v_mfma_f32_16x16x32_bf16 v[48:51], v[128:131], v[36:39], v[48:51]
    v_mfma_f32_16x16x32_bf16 v[52:55], v[132:135], v[36:39], v[52:55]
    v_mfma_f32_16x16x32_bf16 v[48:51], v[160:163], v[40:43], v[48:51]
    v_mfma_f32_16x16x32_bf16 v[52:55], v[164:167], v[40:43], v[52:55]
    v_mfma_f32_16x16x32_bf16 v[48:51], v[144:147], v[44:47], v[48:51]
    v_mfma_f32_16x16x32_bf16 v[52:55], v[148:151], v[44:47], v[52:55]
    ds_read_b32 v221, v209
    ds_read_b128 v[16:19], v227
    ds_read_b128 v[20:23], v11
    ds_read_b128 v[24:27], v11 offset:1024
    ds_read_b128 v[176:179], v229 offset:1536
    ds_read_b128 v[180:183], v229 offset:1600
    ds_read_b128 v[184:187], v229 offset:1792
    ds_read_b128 v[188:191], v229 offset:1856
    v_mov_b64 v[94:95], v[80:81]
    v_mov_b64 v[96:97], v[80:81]
    v_mov_b64 v[98:99], v[80:81]
    v_mov_b64 v[100:101], v[80:81]
    v_mov_b64 v[102:103], v[80:81]
    v_mov_b64 v[104:105], v[80:81]
    v_mov_b64 v[106:107], v[80:81]
    v_mov_b64 v[108:109], v[80:81]
    v_mov_b64 v[110:111], v[80:81]
    v_mov_b64 v[64:65], 0
    v_mov_b64 v[66:67], 0
    v_mov_b64 v[68:69], 0
    v_mov_b64 v[70:71], 0
    v_mov_b64 v[72:73], 0
    v_mov_b64 v[74:75], 0
    v_mov_b64 v[76:77], 0
    v_mov_b64 v[78:79], 0
    s_waitcnt lgkmcnt(7)
pw_3:
    v_cmp_lt_u32 vcc, v221, v5
    s_nop 0
    s_and_b32 s30, vcc_lo, s75
    s_cbranch_scc1 pw_3f
pw_3o:
pw_4:
    v_add_u32 v221, 2, v221
    v_cmp_lt_u32 vcc, v221, v5
    s_nop 0
    s_and_b32 s30, vcc_lo, s79
    s_cbranch_scc1 pw_4f
pw_4o:
    s_waitcnt lgkmcnt(6)
    v_pk_add_f32 v[16:17], v[16:17], v[18:19]
    v_mul_f32 v16, 0xbb000000, v16
    v_mul_f32 v17, 0x3b000000, v17
    v_fma_f32 v17, -v16, v16, v17
    v_max_f32 v17, 0, v17
    v_add_f32 v17, 0x3727c5ac, v17
    v_rsq_f32 v214, v17
    s_nop 0
    v_mul_f32 v212, v16, v214
    v_mul_f32 v215, 0x3eb8aa3b, v214
    v_mul_f32 v213, 0x3eb8aa3b, v212
    v_mov_b32 v214, v215
    v_mov_b32 v212, v213
    s_waitcnt lgkmcnt(4)
    v_pk_add_f32 v[48:49], v[48:49], v[20:21]
    v_pk_add_f32 v[50:51], v[50:51], v[22:23]
    v_pk_add_f32 v[52:53], v[52:53], v[24:25]
    v_pk_add_f32 v[54:55], v[54:55], v[26:27]
    v_pk_mul_f32 v[48:49], v[48:49], v[214:215]
    v_pk_mul_f32 v[50:51], v[50:51], v[214:215]
    v_pk_mul_f32 v[52:53], v[52:53], v[214:215]
    v_pk_mul_f32 v[54:55], v[54:55], v[214:215]
    s_waitcnt lgkmcnt(0)
    v_pk_add_f32 v[176:177], v[176:177], v[184:185]
    v_pk_add_f32 v[178:179], v[178:179], v[186:187]
    v_pk_add_f32 v[180:181], v[180:181], v[188:189]
    v_pk_add_f32 v[182:183], v[182:183], v[190:191]
    v_pk_fma_f32 v[48:49], v[176:177], v[212:213], v[48:49]
    v_pk_fma_f32 v[50:51], v[178:179], v[212:213], v[50:51]
    v_pk_fma_f32 v[52:53], v[180:181], v[212:213], v[52:53]
    v_pk_fma_f32 v[54:55], v[182:183], v[212:213], v[54:55]
    v_cvt_pk_bf16_f32 v192, v48, v49
    v_cvt_pk_bf16_f32 v193, v50, v51
    v_cvt_pk_bf16_f32 v194, v52, v53
    v_cvt_pk_bf16_f32 v195, v54, v55
    ds_write_b128 v225, v[192:195]
    v_mov_b64 v[48:49], 0
    v_mov_b64 v[50:51], 0
    v_mov_b64 v[52:53], 0
    v_mov_b64 v[54:55], 0
    v_mov_b64 v[56:57], 0
    v_mov_b64 v[58:59], 0
    v_mov_b64 v[60:61], 0
    v_mov_b64 v[62:63], 0
    s_cmp_lt_u32 s22, 4
    s_cselect_b32 s101, 0x40000000, s76
    s_cbranch_scc0 noprio
    s_setprio 1
noprio:
    s_waitcnt lgkmcnt(0)
    s_barrier
    ds_read_b128 v[128:131], v255
    ds_read_b128 v[132:135], v210
    s_add_u32 s55, s57, 0x0
    s_and_b32 s55, s55, 0xffff
    buffer_load_dwordx4 v[112:115], v3, s[8:11], s55 offen offset:0 sc1
    s_mov_b64 exec, s[44:45]
    buffer_load_dwordx4 v[80:83], v4, s[8:11], s55 offen offset:1024 sc1
    buffer_load_dwordx4 v[84:87], v4, s[8:11], s55 offen offset:1536 sc1
    s_mov_b64 exec, -1
    buffer_load_dwordx4 v[116:119], v3, s[8:11], s55 offen offset:2048 sc1
    s_mov_b64 exec, s[44:45]
    buffer_load_dwordx4 v[88:91], v4, s[8:11], s55 offen offset:3072 sc1
    buffer_load_dwordx4 v[92:95], v4, s[8:11], s55 offen offset:3584 sc1
    s_mov_b64 exec, -1
    s_waitcnt lgkmcnt(0)
    s_waitcnt vmcnt(3)
    v_max3_u32 v9, v112, v80, v84
    v_cmp_eq_u32 vcc, -1, v9
    s_nop 0
    s_cbranch_vccnz aa_fail0
aa_ok0:
    v_mfma_f32_32x32x16_bf16 v[16:31], v[112:115], v[128:131], 4.0
    s_setprio 3
    s_nop 10
    v_exp_f32 v16, v16
    v_exp_f32 v17, v17
    s_add_u32 s55, s57, 0x1000
    s_and_b32 s55, s55, 0xffff
    buffer_load_dwordx4 v[120:123], v3, s[8:11], s55 offen offset:0 sc1
    s_mov_b64 exec, s[44:45]
    buffer_load_dwordx4 v[96:99], v4, s[8:11], s55 offen offset:1024 sc1
    buffer_load_dwordx4 v[100:103], v4, s[8:11], s55 offen offset:1536 sc1
    s_mov_b64 exec, -1
    v_exp_f32 v18, v18
    v_exp_f32 v19, v19
    v_exp_f32 v20, v20
    v_mfma_f32_32x32x16_bf16 v[32:47], v[112:115], v[132:135], 4.0
    v_exp_f32 v21, v21
    v_exp_f32 v22, v22
    v_exp_f32 v23, v23
    v_exp_f32 v24, v24
    v_exp_f32 v25, v25
    v_exp_f32 v26, v26
    v_smfmac_f32_32x32x32_bf16 v[48:63], v[80:83], v[16:23], v12
    s_mov_b64 exec, 1
    buffer_store_dword v254, v1, s[8:11], s40 offen sc1
    s_mov_b64 exec, -1
    v_exp_f32 v27, v27
    v_exp_f32 v28, v28
    v_exp_f32 v29, v29
    v_exp_f32 v30, v30
    v_exp_f32 v31, v31
    v_exp_f32 v32, v32
    v_exp_f32 v33, v33
    v_smfmac_f32_32x32x32_bf16 v[48:63], v[84:87], v[24:31], v12
    s_waitcnt vmcnt(4)
    v_max3_u32 v9, v116, v88, v92
    v_cmp_eq_u32 vcc, -1, v9
    buffer_load_dwordx4 v[124:127], v3, s[8:11], s55 offen offset:2048 sc1
    s_mov_b64 exec, s[44:45]
    buffer_load_dwordx4 v[104:107], v4, s[8:11], s55 offen offset:3072 sc1
    buffer_load_dwordx4 v[108:111], v4, s[8:11], s55 offen offset:3584 sc1
    s_mov_b64 exec, -1
    v_exp_f32 v34, v34
    v_exp_f32 v35, v35
    v_exp_f32 v36, v36
    s_cbranch_vccnz aa_fail1
aa_ok1:
    v_mfma_f32_32x32x16_bf16 v[16:31], v[116:119], v[128:131], 4.0
    v_exp_f32 v37, v37
    v_exp_f32 v38, v38
    v_exp_f32 v39, v39
    v_exp_f32 v40, v40
    v_exp_f32 v41, v41
    v_exp_f32 v42, v42
    v_smfmac_f32_32x32x32_bf16 v[64:79], v[80:83], v[32:39], v12
    v_exp_f32 v43, v43
    v_exp_f32 v44, v44
    v_exp_f32 v45, v45
    v_exp_f32 v46, v46
    v_exp_f32 v47, v47
    v_exp_f32 v16, v16
    v_exp_f32 v17, v17
    v_smfmac_f32_32x32x32_bf16 v[64:79], v[84:87], v[40:47], v12
    s_add_u32 s55, s57, 0x2000
    s_and_b32 s55, s55, 0xffff
    buffer_load_dwordx4 v[112:115], v3, s[8:11], s55 offen offset:0 sc1
    s_mov_b64 exec, s[44:45]
    buffer_load_dwordx4 v[80:83], v4, s[8:11], s55 offen offset:1024 sc1
    buffer_load_dwordx4 v[84:87], v4, s[8:11], s55 offen offset:1536 sc1
    s_mov_b64 exec, -1
    v_exp_f32 v18, v18
    v_exp_f32 v19, v19
    v_exp_f32 v20, v20
    v_mfma_f32_32x32x16_bf16 v[32:47], v[116:119], v[132:135], 4.0
    v_exp_f32 v21, v21
    v_exp_f32 v22, v22
    v_exp_f32 v23, v23
    v_exp_f32 v24, v24
    v_exp_f32 v25, v25
    v_exp_f32 v26, v26
    v_smfmac_f32_32x32x32_bf16 v[48:63], v[88:91], v[16:23], v12
    v_exp_f32 v27, v27
    v_exp_f32 v28, v28
    v_exp_f32 v29, v29
    v_exp_f32 v30, v30
    v_exp_f32 v31, v31
    v_exp_f32 v32, v32
    v_exp_f32 v33, v33
    v_smfmac_f32_32x32x32_bf16 v[48:63], v[92:95], v[24:31], v12
    s_waitcnt vmcnt(7)
    v_max3_u32 v9, v120, v96, v100
    v_cmp_eq_u32 vcc, -1, v9
    v_exp_f32 v34, v34
    v_exp_f32 v35, v35
    v_exp_f32 v36, v36
    s_cbranch_vccnz aa_fail2
aa_ok2:
    v_mfma_f32_32x32x16_bf16 v[16:31], v[120:123], v[128:131], 4.0
    v_exp_f32 v37, v37
    v_exp_f32 v38, v38
    v_exp_f32 v39, v39
    v_exp_f32 v40, v40
    v_exp_f32 v41, v41
    v_exp_f32 v42, v42
    v_smfmac_f32_32x32x32_bf16 v[64:79], v[88:91], v[32:39], v12
    v_exp_f32 v43, v43
    v_exp_f32 v44, v44
    v_exp_f32 v45, v45
    v_exp_f32 v46, v46
    v_exp_f32 v47, v47
    v_exp_f32 v16, v16
    v_exp_f32 v17, v17
    v_smfmac_f32_32x32x32_bf16 v[64:79], v[92:95], v[40:47], v12
    buffer_load_dwordx4 v[116:119], v3, s[8:11], s55 offen offset:2048 sc1
    s_mov_b64 exec, s[44:45]
    buffer_load_dwordx4 v[88:91], v4, s[8:11], s55 offen offset:3072 sc1
    buffer_load_dwordx4 v[92:95], v4, s[8:11], s55 offen offset:3584 sc1
    s_mov_b64 exec, -1
    v_exp_f32 v18, v18
    v_exp_f32 v19, v19
    v_exp_f32 v20, v20
    v_mfma_f32_32x32x16_bf16 v[32:47], v[120:123], v[132:135], 4.0
    v_exp_f32 v21, v21
    v_exp_f32 v22, v22
    v_exp_f32 v23, v23
    v_exp_f32 v24, v24
    v_exp_f32 v25, v25
    v_exp_f32 v26, v26
    v_smfmac_f32_32x32x32_bf16 v[48:63], v[96:99], v[16:23], v12
    v_exp_f32 v27, v27
    v_exp_f32 v28, v28
    v_exp_f32 v29, v29
    v_exp_f32 v30, v30
    v_exp_f32 v31, v31
    v_exp_f32 v32, v32
    v_exp_f32 v33, v33
    v_smfmac_f32_32x32x32_bf16 v[48:63], v[100:103], v[24:31], v12
    s_waitcnt vmcnt(6)
    v_max3_u32 v9, v124, v104, v108
    v_cmp_eq_u32 vcc, -1, v9
    v_exp_f32 v34, v34
    v_exp_f32 v35, v35
    v_exp_f32 v36, v36
    s_cbranch_vccnz aa_fail3
aa_ok3:
    v_mfma_f32_32x32x16_bf16 v[16:31], v[124:127], v[128:131], 4.0
    v_exp_f32 v37, v37
    v_exp_f32 v38, v38
    v_exp_f32 v39, v39
    v_exp_f32 v40, v40
    v_exp_f32 v41, v41
    v_exp_f32 v42, v42
    v_smfmac_f32_32x32x32_bf16 v[64:79], v[96:99], v[32:39], v12
    v_exp_f32 v43, v43
    v_exp_f32 v44, v44
    v_exp_f32 v45, v45
    v_exp_f32 v46, v46
    v_exp_f32 v47, v47
    v_exp_f32 v16, v16
    v_exp_f32 v17, v17
    v_smfmac_f32_32x32x32_bf16 v[64:79], v[100:103], v[40:47], v12
    s_add_u32 s55, s57, 0x3000
    s_and_b32 s55, s55, 0xffff
    buffer_load_dwordx4 v[120:123], v3, s[8:11], s55 offen offset:0 sc1
    s_mov_b64 exec, s[44:45]
    buffer_load_dwordx4 v[96:99], v4, s[8:11], s55 offen offset:1024 sc1
    buffer_load_dwordx4 v[100:103], v4, s[8:11], s55 offen offset:1536 sc1
    s_mov_b64 exec, -1
    v_exp_f32 v18, v18
    v_exp_f32 v19, v19
    v_exp_f32 v20, v20
    v_mfma_f32_32x32x16_bf16 v[32:47], v[124:127], v[132:135], 4.0
    v_exp_f32 v21, v21
    v_exp_f32 v22, v22
    v_exp_f32 v23, v23
    v_exp_f32 v24, v24
    v_exp_f32 v25, v25
    v_exp_f32 v26, v26
    v_smfmac_f32_32x32x32_bf16 v[48:63], v[104:107], v[16:23], v12
    v_exp_f32 v27, v27
    v_exp_f32 v28, v28
    v_exp_f32 v29, v29
    v_exp_f32 v30, v30
    v_exp_f32 v31, v31
    v_exp_f32 v32, v32
    v_exp_f32 v33, v33
    v_smfmac_f32_32x32x32_bf16 v[48:63], v[108:111], v[24:31], v12
    s_waitcnt vmcnt(6)
    v_max3_u32 v9, v112, v80, v84
    v_cmp_eq_u32 vcc, -1, v9
    v_exp_f32 v34, v34
    v_exp_f32 v35, v35
    v_exp_f32 v36, v36
    s_cbranch_vccnz aa_fail4
aa_ok4:
    v_mfma_f32_32x32x16_bf16 v[16:31], v[112:115], v[128:131], 4.0
    v_exp_f32 v37, v37
    v_exp_f32 v38, v38
    v_exp_f32 v39, v39
    v_exp_f32 v40, v40
    v_exp_f32 v41, v41
    v_exp_f32 v42, v42
    v_smfmac_f32_32x32x32_bf16 v[64:79], v[104:107], v[32:39], v12
    v_exp_f32 v43, v43
    v_exp_f32 v44, v44
    v_exp_f32 v45, v45
    v_exp_f32 v46, v46
    v_exp_f32 v47, v47
    s_setprio 2
    v_exp_f32 v16, v16
    v_exp_f32 v17, v17
    v_smfmac_f32_32x32x32_bf16 v[64:79], v[108:111], v[40:47], v12
    buffer_load_dwordx4 v[124:127], v3, s[8:11], s55 offen offset:2048 sc1
    s_mov_b64 exec, s[44:45]
    buffer_load_dwordx4 v[104:107], v4, s[8:11], s55 offen offset:3072 sc1
    buffer_load_dwordx4 v[108:111], v4, s[8:11], s55 offen offset:3584 sc1
    s_mov_b64 exec, -1
    v_exp_f32 v18, v18
    v_exp_f32 v19, v19
    v_exp_f32 v20, v20
    v_mfma_f32_32x32x16_bf16 v[32:47], v[112:115], v[132:135], 4.0
    v_exp_f32 v21, v21
    v_exp_f32 v22, v22
    v_exp_f32 v23, v23
    v_exp_f32 v24, v24
    v_exp_f32 v25, v25
    v_exp_f32 v26, v26
    v_smfmac_f32_32x32x32_bf16 v[48:63], v[80:83], v[16:23], v12
    v_exp_f32 v27, v27
    v_exp_f32 v28, v28
    v_exp_f32 v29, v29
    v_exp_f32 v30, v30
    v_exp_f32 v31, v31
    v_exp_f32 v32, v32
    v_exp_f32 v33, v33
    v_smfmac_f32_32x32x32_bf16 v[48:63], v[84:87], v[24:31], v12
    s_waitcnt vmcnt(6)
    v_max3_u32 v9, v116, v88, v92
    v_cmp_eq_u32 vcc, -1, v9
    v_exp_f32 v34, v34
    v_exp_f32 v35, v35
    v_exp_f32 v36, v36
    s_cbranch_vccnz aa_fail5
aa_ok5:
    v_mfma_f32_32x32x16_bf16 v[16:31], v[116:119], v[128:131], 4.0
    v_exp_f32 v37, v37
    v_exp_f32 v38, v38
    v_exp_f32 v39, v39
    v_exp_f32 v40, v40
    v_exp_f32 v41, v41
    v_exp_f32 v42, v42
    v_smfmac_f32_32x32x32_bf16 v[64:79], v[80:83], v[32:39], v12
    v_exp_f32 v43, v43
    v_exp_f32 v44, v44
    v_exp_f32 v45, v45
    v_exp_f32 v46, v46
    v_exp_f32 v47, v47
    v_exp_f32 v16, v16
    v_exp_f32 v17, v17
    v_smfmac_f32_32x32x32_bf16 v[64:79], v[84:87], v[40:47], v12
    s_add_u32 s55, s57, 0x4000
    s_and_b32 s55, s55, 0xffff
    buffer_load_dwordx4 v[112:115], v3, s[8:11], s55 offen offset:0 sc1
    s_mov_b64 exec, s[44:45]
    buffer_load_dwordx4 v[80:83], v4, s[8:11], s55 offen offset:1024 sc1
    buffer_load_dwordx4 v[84:87], v4, s[8:11], s55 offen offset:1536 sc1
    s_mov_b64 exec, -1
    v_exp_f32 v18, v18
    v_exp_f32 v19, v19
    v_exp_f32 v20, v20
    v_mfma_f32_32x32x16_bf16 v[32:47], v[116:119], v[132:135], 4.0
    v_exp_f32 v21, v21
    v_exp_f32 v22, v22
    v_exp_f32 v23, v23
    v_exp_f32 v24, v24
    v_exp_f32 v25, v25
    v_exp_f32 v26, v26
    v_smfmac_f32_32x32x32_bf16 v[48:63], v[88:91], v[16:23], v12
    s_lshl_b32 s26, s25, 10
    s_add_u32 s26, s26, 0x40000
    buffer_load_dwordx4 v[240:243], v1, s[8:11], s26 offen sc1
    v_and_b32 v6, 7, v2
    v_lshlrev_b32 v6, 2, v6
    s_lshl_b32 s26, s20, 5
    s_add_u32 s26, s26, 0x40000
    buffer_load_dword v248, v6, s[8:11], s26 offen sc1
    v_exp_f32 v27, v27
    v_exp_f32 v28, v28
    v_exp_f32 v29, v29
    v_exp_f32 v30, v30
    v_exp_f32 v31, v31
    v_exp_f32 v32, v32
    v_exp_f32 v33, v33
    v_smfmac_f32_32x32x32_bf16 v[48:63], v[92:95], v[24:31], v12
    s_waitcnt vmcnt(8)
    v_max3_u32 v9, v120, v96, v100
    v_cmp_eq_u32 vcc, -1, v9
    v_exp_f32 v34, v34
    v_exp_f32 v35, v35
    v_exp_f32 v36, v36
    s_cbranch_vccnz aa_fail6
aa_ok6:
    v_mfma_f32_32x32x16_bf16 v[16:31], v[120:123], v[128:131], 4.0
    v_exp_f32 v37, v37
    v_exp_f32 v38, v38
    v_exp_f32 v39, v39
    v_exp_f32 v40, v40
    v_exp_f32 v41, v41
    v_exp_f32 v42, v42
    v_smfmac_f32_32x32x32_bf16 v[64:79], v[88:91], v[32:39], v12
    v_exp_f32 v43, v43
    v_exp_f32 v44, v44
    v_exp_f32 v45, v45
    v_exp_f32 v46, v46
    v_exp_f32 v47, v47
    v_exp_f32 v16, v16
    v_exp_f32 v17, v17
    v_smfmac_f32_32x32x32_bf16 v[64:79], v[92:95], v[40:47], v12
    buffer_load_dwordx4 v[116:119], v3, s[8:11], s55 offen offset:2048 sc1
    s_mov_b64 exec, s[44:45]
    buffer_load_dwordx4 v[88:91], v4, s[8:11], s55 offen offset:3072 sc1
    buffer_load_dwordx4 v[92:95], v4, s[8:11], s55 offen offset:3584 sc1
    s_mov_b64 exec, -1
    v_exp_f32 v18, v18
    v_exp_f32 v19, v19
    v_exp_f32 v20, v20
    v_mfma_f32_32x32x16_bf16 v[32:47], v[120:123], v[132:135], 4.0
    v_exp_f32 v21, v21
    v_exp_f32 v22, v22
    v_exp_f32 v23, v23
    v_exp_f32 v24, v24
    v_exp_f32 v25, v25
    v_exp_f32 v26, v26
    v_smfmac_f32_32x32x32_bf16 v[48:63], v[96:99], v[16:23], v12
    v_exp_f32 v27, v27
    v_exp_f32 v28, v28
    v_exp_f32 v29, v29
    v_exp_f32 v30, v30
    v_exp_f32 v31, v31
    v_exp_f32 v32, v32
    v_exp_f32 v33, v33
    v_smfmac_f32_32x32x32_bf16 v[48:63], v[100:103], v[24:31], v12
    s_waitcnt vmcnt(8)
    v_max3_u32 v9, v124, v104, v108
    v_cmp_eq_u32 vcc, -1, v9
    v_exp_f32 v34, v34
    v_exp_f32 v35, v35
    v_exp_f32 v36, v36
    s_cbranch_vccnz aa_fail7
aa_ok7:
    v_mfma_f32_32x32x16_bf16 v[16:31], v[124:127], v[128:131], 4.0
    v_exp_f32 v37, v37
    v_exp_f32 v38, v38
    v_exp_f32 v39, v39
    v_exp_f32 v40, v40
    v_exp_f32 v41, v41
    v_exp_f32 v42, v42
    v_smfmac_f32_32x32x32_bf16 v[64:79], v[96:99], v[32:39], v12
    v_exp_f32 v43, v43
    v_exp_f32 v44, v44
    v_exp_f32 v45, v45
    v_exp_f32 v46, v46
    v_exp_f32 v47, v47
    v_exp_f32 v16, v16
    v_exp_f32 v17, v17
    v_smfmac_f32_32x32x32_bf16 v[64:79], v[100:103], v[40:47], v12
    s_add_u32 s55, s57, 0x5000
    s_and_b32 s55, s55, 0xffff
    buffer_load_dwordx4 v[120:123], v3, s[8:11], s55 offen offset:0 sc1
    s_mov_b64 exec, s[44:45]
    buffer_load_dwordx4 v[96:99], v4, s[8:11], s55 offen offset:1024 sc1
    buffer_load_dwordx4 v[100:103], v4, s[8:11], s55 offen offset:1536 sc1
    s_mov_b64 exec, -1
    v_exp_f32 v18, v18
    v_exp_f32 v19, v19
    v_exp_f32 v20, v20
    v_mfma_f32_32x32x16_bf16 v[32:47], v[124:127], v[132:135], 4.0
    v_exp_f32 v21, v21
    v_exp_f32 v22, v22
    v_exp_f32 v23, v23
    v_exp_f32 v24, v24
    v_exp_f32 v25, v25
    v_exp_f32 v26, v26
    v_smfmac_f32_32x32x32_bf16 v[48:63], v[104:107], v[16:23], v12
    s_waitcnt vmcnt(6)
aa_xtc:
    v_max3_u32 v9, v240, v241, v242
    v_max3_u32 v9, v9, v243, v248
    v_cmp_eq_u32 vcc, -1, v9
    s_nop 0
    s_cbranch_vccnz aa_xtf
aa_xto:
    v_readfirstlane_b32 s28, v248
    s_nop 1
    v_cmp_ne_u32 vcc, s28, v248
    s_nop 0
    s_cmp_eq_u64 vcc, 0
    s_cselect_b32 s43, 1, 0
    s_cmp_gt_u32 s28, 15
    s_cselect_b32 s43, 0, s43
    v_mov_b32 v244, -1
    v_mov_b32 v245, -1
    v_mov_b32 v246, -1
    v_mov_b32 v247, -1
    v_exp_f32 v27, v27
    v_exp_f32 v28, v28
    v_exp_f32 v29, v29
    v_exp_f32 v30, v30
    v_exp_f32 v31, v31
    v_exp_f32 v32, v32
    v_exp_f32 v33, v33
    v_smfmac_f32_32x32x32_bf16 v[48:63], v[108:111], v[24:31], v12
    v_max3_u32 v9, v112, v80, v84
    v_cmp_eq_u32 vcc, -1, v9
    v_exp_f32 v34, v34
    v_exp_f32 v35, v35
    v_exp_f32 v36, v36
    s_cbranch_vccnz aa_fail8
aa_ok8:
    v_mfma_f32_32x32x16_bf16 v[16:31], v[112:115], v[128:131], 4.0
    v_exp_f32 v37, v37
    v_exp_f32 v38, v38
    v_exp_f32 v39, v39
    v_exp_f32 v40, v40
    v_exp_f32 v41, v41
    v_exp_f32 v42, v42
    v_smfmac_f32_32x32x32_bf16 v[64:79], v[104:107], v[32:39], v12
    s_add_u32 s33, s37, 0x0
    buffer_store_dwordx4 v[244:247], v223, s[8:11], s33 offen sc1
    s_add_u32 s33, s77, 0x0
    s_cmp_lg_u32 s43, 0
    s_cbranch_scc0 ps_5
    buffer_store_dwordx4 v[244:247], v14, s[8:11], s33 offen
ps_6:
    v_exp_f32 v43, v43
    v_exp_f32 v44, v44
    v_exp_f32 v45, v45
    v_exp_f32 v46, v46
    v_exp_f32 v47, v47
    v_exp_f32 v16, v16
    v_exp_f32 v17, v17
    v_smfmac_f32_32x32x32_bf16 v[64:79], v[108:111], v[40:47], v12
    buffer_load_dwordx4 v[124:127], v3, s[8:11], s55 offen offset:2048
    s_mov_b64 exec, s[44:45]
    buffer_load_dwordx4 v[104:107], v4, s[8:11], s55 offen offset:3072
    buffer_load_dwordx4 v[108:111], v4, s[8:11], s55 offen offset:3584
    s_mov_b64 exec, -1
    v_exp_f32 v18, v18
    v_exp_f32 v19, v19
    v_exp_f32 v20, v20
    v_mfma_f32_32x32x16_bf16 v[32:47], v[112:115], v[132:135], 4.0
    v_exp_f32 v21, v21
    v_exp_f32 v22, v22
    v_exp_f32 v23, v23
    v_exp_f32 v24, v24
    v_exp_f32 v25, v25
    v_exp_f32 v26, v26
    v_smfmac_f32_32x32x32_bf16 v[48:63], v[80:83], v[16:23], v12
    s_add_u32 s33, s35, 0x10000
    s_cmp_lg_u32 s43, 0
    s_cbranch_scc0 ps_7
    buffer_store_dwordx4 v[244:247], v1, s[8:11], s33 offen
ps_8:
    v_exp_f32 v27, v27
    v_exp_f32 v28, v28
    v_exp_f32 v29, v29
    v_exp_f32 v30, v30
    v_exp_f32 v31, v31
    v_exp_f32 v32, v32
    v_exp_f32 v33, v33
    v_smfmac_f32_32x32x32_bf16 v[48:63], v[84:87], v[24:31], v12
    s_waitcnt vmcnt(9)
    v_max3_u32 v9, v116, v88, v92
    v_cmp_eq_u32 vcc, -1, v9
    v_exp_f32 v34, v34
    v_exp_f32 v35, v35
    v_exp_f32 v36, v36
    s_cbranch_vccnz aa_fail9
aa_ok9:
    v_mfma_f32_32x32x16_bf16 v[16:31], v[116:119], v[128:131], 4.0
    v_exp_f32 v37, v37
    v_exp_f32 v38, v38
    v_exp_f32 v39, v39
    v_exp_f32 v40, v40
    v_exp_f32 v41, v41
    v_exp_f32 v42, v42
    v_smfmac_f32_32x32x32_bf16 v[64:79], v[80:83], v[32:39], v12
    s_add_u32 s33, s37, 0x0
    buffer_store_dwordx4 v[244:247], v224, s[8:11], s33 offen sc1
    v_exp_f32 v43, v43
    v_exp_f32 v44, v44
    v_exp_f32 v45, v45
    v_exp_f32 v46, v46
    v_exp_f32 v47, v47
    v_exp_f32 v16, v16
    v_exp_f32 v17, v17
    v_smfmac_f32_32x32x32_bf16 v[64:79], v[84:87], v[40:47], v12
    s_add_u32 s55, s57, 0x6000
    s_and_b32 s55, s55, 0xffff
    buffer_load_dwordx4 v[112:115], v3, s[8:11], s55 offen offset:0
    s_mov_b64 exec, s[44:45]
    buffer_load_dwordx4 v[80:83], v4, s[8:11], s55 offen offset:1024
    buffer_load_dwordx4 v[84:87], v4, s[8:11], s55 offen offset:1536
    s_mov_b64 exec, -1
    v_exp_f32 v18, v18
    v_exp_f32 v19, v19
    v_exp_f32 v20, v20
    v_mfma_f32_32x32x16_bf16 v[32:47], v[116:119], v[132:135], 4.0
    v_exp_f32 v21, v21
    v_exp_f32 v22, v22
    v_exp_f32 v23, v23
    v_exp_f32 v24, v24
    v_exp_f32 v25, v25
    v_exp_f32 v26, v26
    v_smfmac_f32_32x32x32_bf16 v[48:63], v[88:91], v[16:23], v12
    s_add_u32 s33, s36, 0x20000
    s_cmp_lg_u32 s43, 0
    s_cbranch_scc0 ps_9
    buffer_store_dwordx4 v[244:247], v14, s[8:11], s33 offen
ps_10:
    v_exp_f32 v27, v27
    v_exp_f32 v28, v28
    v_exp_f32 v29, v29
    v_exp_f32 v30, v30
    v_exp_f32 v31, v31
    v_exp_f32 v32, v32
    v_exp_f32 v33, v33
    v_smfmac_f32_32x32x32_bf16 v[48:63], v[92:95], v[24:31], v12
    s_waitcnt vmcnt(11)
    v_max3_u32 v9, v120, v96, v100
    v_cmp_eq_u32 vcc, -1, v9
    v_exp_f32 v34, v34
    v_exp_f32 v35, v35
    v_exp_f32 v36, v36
    s_cbranch_vccnz aa_fail10
aa_ok10:
    v_mfma_f32_32x32x16_bf16 v[16:31], v[120:123], v[128:131], 4.0
    v_exp_f32 v37, v37
    v_exp_f32 v38, v38
    v_exp_f32 v39, v39
    v_exp_f32 v40, v40
    v_exp_f32 v41, v41
    v_exp_f32 v42, v42
    v_smfmac_f32_32x32x32_bf16 v[64:79], v[88:91], v[32:39], v12
    s_add_u32 s33, s35, 0x30000
    s_lshl_b32 s32, s25, 30
    s_add_u32 s33, s33, s32
    s_cmp_lg_u32 s43, 0
    s_cbranch_scc0 ps_11
    buffer_store_dwordx4 v[244:247], v1, s[8:11], s33 offen
ps_12:
    v_exp_f32 v43, v43
    v_exp_f32 v44, v44
    v_exp_f32 v45, v45
    v_exp_f32 v46, v46
    v_exp_f32 v47, v47
    v_exp_f32 v16, v16
    v_exp_f32 v17, v17
    v_smfmac_f32_32x32x32_bf16 v[64:79], v[92:95], v[40:47], v12
    buffer_load_dwordx4 v[116:119], v3, s[8:11], s55 offen offset:2048
    s_mov_b64 exec, s[44:45]
    buffer_load_dwordx4 v[88:91], v4, s[8:11], s55 offen offset:3072
    buffer_load_dwordx4 v[92:95], v4, s[8:11], s55 offen offset:3584
    s_mov_b64 exec, -1
    v_exp_f32 v18, v18
    v_exp_f32 v19, v19
    v_exp_f32 v20, v20
    v_mfma_f32_32x32x16_bf16 v[32:47], v[120:123], v[132:135], 4.0
    v_exp_f32 v21, v21
    v_exp_f32 v22, v22
    v_exp_f32 v23, v23
    v_exp_f32 v24, v24
    v_exp_f32 v25, v25
    v_exp_f32 v26, v26
    v_smfmac_f32_32x32x32_bf16 v[48:63], v[96:99], v[16:23], v12
    s_add_u32 m0, s41, 0x0
    s_add_u32 s33, s39, 0x80000
    buffer_load_dwordx4 v1, s[8:11], s33 offen offset:0 lds
    v_exp_f32 v27, v27
    v_exp_f32 v28, v28
    v_exp_f32 v29, v29
    v_exp_f32 v30, v30
    v_exp_f32 v31, v31
    v_exp_f32 v32, v32
    v_exp_f32 v33, v33
    v_smfmac_f32_32x32x32_bf16 v[48:63], v[100:103], v[24:31], v12
    s_waitcnt vmcnt(11)
    v_exp_f32 v34, v34
    v_exp_f32 v35, v35
    v_exp_f32 v36, v36
    v_mfma_f32_32x32x16_bf16 v[16:31], v[124:127], v[128:131], 4.0
    v_exp_f32 v37, v37
    v_exp_f32 v38, v38
    v_exp_f32 v39, v39
    v_exp_f32 v40, v40
    v_exp_f32 v41, v41
    v_exp_f32 v42, v42
    v_smfmac_f32_32x32x32_bf16 v[64:79], v[96:99], v[32:39], v12
    s_add_u32 m0, s41, 0x0
    s_add_u32 s33, s39, 0x80000
    buffer_load_dwordx4 v1, s[8:11], s33 offen offset:1024 lds
    v_exp_f32 v43, v43
    v_exp_f32 v44, v44
    v_exp_f32 v45, v45
    v_exp_f32 v46, v46
    v_exp_f32 v47, v47
    v_exp_f32 v16, v16
    v_exp_f32 v17, v17
    v_smfmac_f32_32x32x32_bf16 v[64:79], v[100:103], v[40:47], v12
    s_add_u32 s55, s57, 0x7000
    s_and_b32 s55, s55, 0xffff
    buffer_load_dwordx4 v[120:123], v3, s[8:11], s55 offen offset:0
    s_mov_b64 exec, s[44:45]
    buffer_load_dwordx4 v[96:99], v4, s[8:11], s55 offen offset:1024
    buffer_load_dwordx4 v[100:103], v4, s[8:11], s55 offen offset:1536
    s_mov_b64 exec, -1
    v_exp_f32 v18, v18
    v_exp_f32 v19, v19
    v_exp_f32 v20, v20
    v_mfma_f32_32x32x16_bf16 v[32:47], v[124:127], v[132:135], 4.0
    v_exp_f32 v21, v21
    v_exp_f32 v22, v22
    v_exp_f32 v23, v23
    v_exp_f32 v24, v24
    v_exp_f32 v25, v25
    v_exp_f32 v26, v26
    v_smfmac_f32_32x32x32_bf16 v[48:63], v[104:107], v[16:23], v12
    s_add_u32 m0, s41, 0x0
    s_add_u32 s33, s39, 0x80000
    buffer_load_dwordx4 v1, s[8:11], s33 offen offset:2048 lds
    v_exp_f32 v27, v27
    v_exp_f32 v28, v28
    v_exp_f32 v29, v29
    v_exp_f32 v30, v30
    v_exp_f32 v31, v31
    v_exp_f32 v32, v32
    v_exp_f32 v33, v33
    v_smfmac_f32_32x32x32_bf16 v[48:63], v[108:111], v[24:31], v12
    s_waitcnt vmcnt(11)
    v_exp_f32 v34, v34
    v_exp_f32 v35, v35
    v_exp_f32 v36, v36
    v_mfma_f32_32x32x16_bf16 v[16:31], v[112:115], v[128:131], 4.0
    v_exp_f32 v37, v37
    v_exp_f32 v38, v38
    v_exp_f32 v39, v39
    v_exp_f32 v40, v40
    v_exp_f32 v41, v41
    v_exp_f32 v42, v42
    v_smfmac_f32_32x32x32_bf16 v[64:79], v[104:107], v[32:39], v12
    s_add_u32 m0, s41, 0x0
    s_add_u32 s33, s39, 0x80000
    buffer_load_dwordx4 v1, s[8:11], s33 offen offset:3072 lds
    v_exp_f32 v43, v43
    v_exp_f32 v44, v44
    v_exp_f32 v45, v45
    v_exp_f32 v46, v46
    v_exp_f32 v47, v47
    v_exp_f32 v16, v16
    v_exp_f32 v17, v17
    v_smfmac_f32_32x32x32_bf16 v[64:79], v[108:111], v[40:47], v12
    buffer_load_dwordx4 v[124:127], v3, s[8:11], s55 offen offset:2048
    s_mov_b64 exec, s[44:45]
    buffer_load_dwordx4 v[104:107], v4, s[8:11], s55 offen offset:3072
    buffer_load_dwordx4 v[108:111], v4, s[8:11], s55 offen offset:3584
    s_mov_b64 exec, -1
    v_exp_f32 v18, v18
    v_exp_f32 v19, v19
    v_exp_f32 v20, v20
    v_mfma_f32_32x32x16_bf16 v[32:47], v[112:115], v[132:135], 4.0
    v_exp_f32 v21, v21
    v_exp_f32 v22, v22
    v_exp_f32 v23, v23
    v_exp_f32 v24, v24
    v_exp_f32 v25, v25
    v_exp_f32 v26, v26
    v_smfmac_f32_32x32x32_bf16 v[48:63], v[80:83], v[16:23], v12
    s_add_u32 m0, s41, 0x1000
    s_add_u32 s33, s39, 0x81000
    buffer_load_dwordx4 v1, s[8:11], s33 offen offset:0 lds
    v_exp_f32 v27, v27
    v_exp_f32 v28, v28
    v_exp_f32 v29, v29
    v_exp_f32 v30, v30
    v_exp_f32 v31, v31
    v_exp_f32 v32, v32
    v_exp_f32 v33, v33
    v_smfmac_f32_32x32x32_bf16 v[48:63], v[84:87], v[24:31], v12
    s_waitcnt vmcnt(11)
    v_exp_f32 v34, v34
    v_exp_f32 v35, v35
    v_exp_f32 v36, v36
    v_mfma_f32_32x32x16_bf16 v[16:31], v[116:119], v[128:131], 4.0
    v_exp_f32 v37, v37
    v_exp_f32 v38, v38
    v_exp_f32 v39, v39
    v_exp_f32 v40, v40
    v_exp_f32 v41, v41
    v_exp_f32 v42, v42
    v_smfmac_f32_32x32x32_bf16 v[64:79], v[80:83], v[32:39], v12
    s_add_u32 m0, s41, 0x1000
    s_add_u32 s33, s39, 0x81000
    buffer_load_dwordx4 v1, s[8:11], s33 offen offset:1024 lds
    v_exp_f32 v43, v43
    v_exp_f32 v44, v44
    v_exp_f32 v45, v45
    v_exp_f32 v46, v46
    v_exp_f32 v47, v47
    v_exp_f32 v16, v16
    v_exp_f32 v17, v17
    v_smfmac_f32_32x32x32_bf16 v[64:79], v[84:87], v[40:47], v12
    s_add_u32 s55, s57, 0x8000
    s_and_b32 s55, s55, 0xffff
    buffer_load_dwordx4 v[112:115], v3, s[8:11], s55 offen offset:0
    s_mov_b64 exec, s[44:45]
    buffer_load_dwordx4 v[80:83], v4, s[8:11], s55 offen offset:1024
    buffer_load_dwordx4 v[84:87], v4, s[8:11], s55 offen offset:1536
    s_mov_b64 exec, -1
    v_exp_f32 v18, v18
    v_exp_f32 v19, v19
    v_exp_f32 v20, v20
    v_mfma_f32_32x32x16_bf16 v[32:47], v[116:119], v[132:135], 4.0
    v_exp_f32 v21, v21
    v_exp_f32 v22, v22
    v_exp_f32 v23, v23
    v_exp_f32 v24, v24
    v_exp_f32 v25, v25
    v_exp_f32 v26, v26
    v_smfmac_f32_32x32x32_bf16 v[48:63], v[88:91], v[16:23], v12
    s_add_u32 m0, s41, 0x1000
    s_add_u32 s33, s39, 0x81000
    buffer_load_dwordx4 v1, s[8:11], s33 offen offset:2048 lds
    v_exp_f32 v27, v27
    v_exp_f32 v28, v28
    v_exp_f32 v29, v29
    v_exp_f32 v30, v30
    v_exp_f32 v31, v31
    v_exp_f32 v32, v32
    v_exp_f32 v33, v33
    v_smfmac_f32_32x32x32_bf16 v[48:63], v[92:95], v[24:31], v12
    s_waitcnt vmcnt(11)
    v_exp_f32 v34, v34
    v_exp_f32 v35, v35
    v_exp_f32 v36, v36
    v_mfma_f32_32x32x16_bf16 v[16:31], v[120:123], v[128:131], 4.0
    v_exp_f32 v37, v37
    v_exp_f32 v38, v38
    v_exp_f32 v39, v39
    v_exp_f32 v40, v40
    v_exp_f32 v41, v41
    v_exp_f32 v42, v42
    v_smfmac_f32_32x32x32_bf16 v[64:79], v[88:91], v[32:39], v12
    s_add_u32 m0, s41, 0x1000
    s_add_u32 s33, s39, 0x81000
    buffer_load_dwordx4 v1, s[8:11], s33 offen offset:3072 lds
    v_exp_f32 v43, v43
    v_exp_f32 v44, v44
    v_exp_f32 v45, v45
    v_exp_f32 v46, v46
    v_exp_f32 v47, v47
    v_exp_f32 v16, v16
    v_exp_f32 v17, v17
    v_smfmac_f32_32x32x32_bf16 v[64:79], v[92:95], v[40:47], v12
    buffer_load_dwordx4 v[116:119], v3, s[8:11], s55 offen offset:2048
    s_mov_b64 exec, s[44:45]
    buffer_load_dwordx4 v[88:91], v4, s[8:11], s55 offen offset:3072
    buffer_load_dwordx4 v[92:95], v4, s[8:11], s55 offen offset:3584
    s_mov_b64 exec, -1
    v_exp_f32 v18, v18
    v_exp_f32 v19, v19
    v_exp_f32 v20, v20
    v_mfma_f32_32x32x16_bf16 v[32:47], v[120:123], v[132:135], 4.0
    v_exp_f32 v21, v21
    v_exp_f32 v22, v22
    v_exp_f32 v23, v23
    v_exp_f32 v24, v24
    v_exp_f32 v25, v25
    v_exp_f32 v26, v26
    v_smfmac_f32_32x32x32_bf16 v[48:63], v[96:99], v[16:23], v12
    s_add_u32 m0, s41, 0x8000
    s_add_u32 s33, s39, 0x100000
    buffer_load_dwordx4 v1, s[8:11], s33 offen offset:0 lds
    v_exp_f32 v27, v27
    v_exp_f32 v28, v28
    v_exp_f32 v29, v29
    v_exp_f32 v30, v30
    v_exp_f32 v31, v31
    v_exp_f32 v32, v32
    v_exp_f32 v33, v33
    v_smfmac_f32_32x32x32_bf16 v[48:63], v[100:103], v[24:31], v12
    s_waitcnt vmcnt(11)
    v_exp_f32 v34, v34
    v_exp_f32 v35, v35
    v_exp_f32 v36, v36
    v_mfma_f32_32x32x16_bf16 v[16:31], v[124:127], v[128:131], 4.0
    v_exp_f32 v37, v37
    v_exp_f32 v38, v38
    v_exp_f32 v39, v39
    v_exp_f32 v40, v40
    v_exp_f32 v41, v41
    v_exp_f32 v42, v42
    v_smfmac_f32_32x32x32_bf16 v[64:79], v[96:99], v[32:39], v12
    s_add_u32 m0, s41, 0x8000
    s_add_u32 s33, s39, 0x100000
    buffer_load_dwordx4 v1, s[8:11], s33 offen offset:1024 lds
    v_exp_f32 v43, v43
    v_exp_f32 v44, v44
    v_exp_f32 v45, v45
    v_exp_f32 v46, v46
    v_exp_f32 v47, v47
    v_exp_f32 v16, v16
    v_exp_f32 v17, v17
    v_smfmac_f32_32x32x32_bf16 v[64:79], v[100:103], v[40:47], v12
    s_add_u32 s55, s57, 0x9000
    s_and_b32 s55, s55, 0xffff
    buffer_load_dwordx4 v[120:123], v3, s[8:11], s55 offen offset:0
    s_mov_b64 exec, s[44:45]
    buffer_load_dwordx4 v[96:99], v4, s[8:11], s55 offen offset:1024
    buffer_load_dwordx4 v[100:103], v4, s[8:11], s55 offen offset:1536
    s_mov_b64 exec, -1
    v_exp_f32 v18, v18
    v_exp_f32 v19, v19
    v_exp_f32 v20, v20
    v_mfma_f32_32x32x16_bf16 v[32:47], v[124:127], v[132:135], 4.0
    v_exp_f32 v21, v21
    v_exp_f32 v22, v22
    v_exp_f32 v23, v23
    v_exp_f32 v24, v24
    v_exp_f32 v25, v25
    v_exp_f32 v26, v26
    v_smfmac_f32_32x32x32_bf16 v[48:63], v[104:107], v[16:23], v12
    s_add_u32 m0, s41, 0x8000
    s_add_u32 s33, s39, 0x100000
    buffer_load_dwordx4 v1, s[8:11], s33 offen offset:2048 lds
    v_mov_b32 v244, 0
    s_lshl_b32 s32, s20, 1
    s_add_u32 s32, s32, s25
    s_lshl_b32 s32, s32, 3
    s_add_u32 s32, s32, s21
    s_lshl_b32 s32, s32, 3
    s_add_u32 s32, s32, s22
    s_lshl_b32 s32, s32, 2
    s_add_u32 s32, s32, 0x42000
    s_mov_b64 exec, 1
    buffer_store_dword v244, v244, s[8:11], s32 offen sc1
    s_mov_b64 exec, -1
    v_exp_f32 v27, v27
    v_exp_f32 v28, v28
    v_exp_f32 v29, v29
    v_exp_f32 v30, v30
    v_exp_f32 v31, v31
    v_exp_f32 v32, v32
    v_exp_f32 v33, v33
    v_smfmac_f32_32x32x32_bf16 v[48:63], v[108:111], v[24:31], v12
    s_waitcnt vmcnt(12)
    v_exp_f32 v34, v34
    v_exp_f32 v35, v35
    v_exp_f32 v36, v36
    v_mfma_f32_32x32x16_bf16 v[16:31], v[112:115], v[128:131], 4.0
    v_exp_f32 v37, v37
    v_exp_f32 v38, v38
    v_exp_f32 v39, v39
    v_exp_f32 v40, v40
    v_exp_f32 v41, v41
    v_exp_f32 v42, v42
    v_smfmac_f32_32x32x32_bf16 v[64:79], v[104:107], v[32:39], v12
    s_add_u32 m0, s41, 0x8000
    s_add_u32 s33, s39, 0x100000
    buffer_load_dwordx4 v1, s[8:11], s33 offen offset:3072 lds
    v_exp_f32 v43, v43
    v_exp_f32 v44, v44
    v_exp_f32 v45, v45
    v_exp_f32 v46, v46
    v_exp_f32 v47, v47
    v_exp_f32 v16, v16
    v_exp_f32 v17, v17
    v_smfmac_f32_32x32x32_bf16 v[64:79], v[108:111], v[40:47], v12
    buffer_load_dwordx4 v[124:127], v3, s[8:11], s55 offen offset:2048
    s_mov_b64 exec, s[44:45]
    buffer_load_dwordx4 v[104:107], v4, s[8:11], s55 offen offset:3072
    buffer_load_dwordx4 v[108:111], v4, s[8:11], s55 offen offset:3584
    s_mov_b64 exec, -1
    v_exp_f32 v18, v18
    v_exp_f32 v19, v19
    v_exp_f32 v20, v20
    v_mfma_f32_32x32x16_bf16 v[32:47], v[112:115], v[132:135], 4.0
    v_exp_f32 v21, v21
    v_exp_f32 v22, v22
    v_exp_f32 v23, v23
    v_exp_f32 v24, v24
    v_exp_f32 v25, v25
    v_exp_f32 v26, v26
    v_smfmac_f32_32x32x32_bf16 v[48:63], v[80:83], v[16:23], v12
    s_add_u32 m0, s41, 0x9000
    s_add_u32 s33, s39, 0x101000
    buffer_load_dwordx4 v1, s[8:11], s33 offen offset:0 lds
    v_exp_f32 v27, v27
    v_exp_f32 v28, v28
    v_exp_f32 v29, v29
    v_exp_f32 v30, v30
    v_exp_f32 v31, v31
    v_exp_f32 v32, v32
    v_exp_f32 v33, v33
    v_smfmac_f32_32x32x32_bf16 v[48:63], v[84:87], v[24:31], v12
    s_waitcnt vmcnt(12)
    v_exp_f32 v34, v34
    v_exp_f32 v35, v35
    v_exp_f32 v36, v36
    v_mfma_f32_32x32x16_bf16 v[16:31], v[116:119], v[128:131], 4.0
    v_exp_f32 v37, v37
    v_exp_f32 v38, v38
    v_exp_f32 v39, v39
    v_exp_f32 v40, v40
    v_exp_f32 v41, v41
    v_exp_f32 v42, v42
    v_smfmac_f32_32x32x32_bf16 v[64:79], v[80:83], v[32:39], v12
    s_add_u32 m0, s41, 0x9000
    s_add_u32 s33, s39, 0x101000
    buffer_load_dwordx4 v1, s[8:11], s33 offen offset:1024 lds
    v_exp_f32 v43, v43
    v_exp_f32 v44, v44
    v_exp_f32 v45, v45
    v_exp_f32 v46, v46
    v_exp_f32 v47, v47
    s_setprio 1
    v_exp_f32 v16, v16
    v_exp_f32 v17, v17
    v_smfmac_f32_32x32x32_bf16 v[64:79], v[84:87], v[40:47], v12
    s_add_u32 s55, s57, 0xa000
    s_and_b32 s55, s55, 0xffff
    buffer_load_dwordx4 v[112:115], v3, s[8:11], s55 offen offset:0
    s_mov_b64 exec, s[44:45]
    buffer_load_dwordx4 v[80:83], v4, s[8:11], s55 offen offset:1024
    buffer_load_dwordx4 v[84:87], v4, s[8:11], s55 offen offset:1536
    s_mov_b64 exec, -1
    v_exp_f32 v18, v18
    v_exp_f32 v19, v19
    v_exp_f32 v20, v20
    v_mfma_f32_32x32x16_bf16 v[32:47], v[116:119], v[132:135], 4.0
    v_exp_f32 v21, v21
    v_exp_f32 v22, v22
    v_exp_f32 v23, v23
    v_exp_f32 v24, v24
    v_exp_f32 v25, v25
    v_exp_f32 v26, v26
    v_smfmac_f32_32x32x32_bf16 v[48:63], v[88:91], v[16:23], v12
    s_add_u32 m0, s41, 0x9000
    s_add_u32 s33, s39, 0x101000
    buffer_load_dwordx4 v1, s[8:11], s33 offen offset:2048 lds
    v_exp_f32 v27, v27
    v_exp_f32 v28, v28
    v_exp_f32 v29, v29
    v_exp_f32 v30, v30
    v_exp_f32 v31, v31
    v_exp_f32 v32, v32
    v_exp_f32 v33, v33
    v_smfmac_f32_32x32x32_bf16 v[48:63], v[92:95], v[24:31], v12
    s_waitcnt vmcnt(12)
    v_exp_f32 v34, v34
    v_exp_f32 v35, v35
    v_exp_f32 v36, v36
    v_mfma_f32_32x32x16_bf16 v[16:31], v[120:123], v[128:131], 4.0
    v_exp_f32 v37, v37
    v_exp_f32 v38, v38
    v_exp_f32 v39, v39
    v_exp_f32 v40, v40
    v_exp_f32 v41, v41
    v_exp_f32 v42, v42
    v_smfmac_f32_32x32x32_bf16 v[64:79], v[88:91], v[32:39], v12
    s_add_u32 m0, s41, 0x9000
    s_add_u32 s33, s39, 0x101000
    buffer_load_dwordx4 v1, s[8:11], s33 offen offset:3072 lds
    v_exp_f32 v43, v43
    v_exp_f32 v44, v44
    v_exp_f32 v45, v45
    v_exp_f32 v46, v46
    v_exp_f32 v47, v47
    v_exp_f32 v16, v16
    v_exp_f32 v17, v17
    v_smfmac_f32_32x32x32_bf16 v[64:79], v[92:95], v[40:47], v12
    buffer_load_dwordx4 v[116:119], v3, s[8:11], s55 offen offset:2048
    s_mov_b64 exec, s[44:45]
    buffer_load_dwordx4 v[88:91], v4, s[8:11], s55 offen offset:3072
    buffer_load_dwordx4 v[92:95], v4, s[8:11], s55 offen offset:3584
    s_mov_b64 exec, -1
    v_exp_f32 v18, v18
    v_exp_f32 v19, v19
    v_exp_f32 v20, v20
    v_mfma_f32_32x32x16_bf16 v[32:47], v[120:123], v[132:135], 4.0
    v_exp_f32 v21, v21
    v_exp_f32 v22, v22
    v_exp_f32 v23, v23
    v_exp_f32 v24, v24
    v_exp_f32 v25, v25
    v_exp_f32 v26, v26
    v_smfmac_f32_32x32x32_bf16 v[48:63], v[96:99], v[16:23], v12
    s_add_u32 s33, s56, 0x180000
    buffer_load_dwordx4 v[248:251], v1, s[8:11], s33 offen
    s_add_u32 s33, s56, 0x180400
    buffer_load_dwordx4 v[248:251], v1, s[8:11], s33 offen
    v_exp_f32 v27, v27
    v_exp_f32 v28, v28
    v_exp_f32 v29, v29
    v_exp_f32 v30, v30
    v_exp_f32 v31, v31
    v_exp_f32 v32, v32
    v_exp_f32 v33, v33
    v_smfmac_f32_32x32x32_bf16 v[48:63], v[100:103], v[24:31], v12
    s_waitcnt vmcnt(12)
    v_exp_f32 v34, v34
    v_exp_f32 v35, v35
    v_exp_f32 v36, v36
    v_mfma_f32_32x32x16_bf16 v[16:31], v[124:127], v[128:131], 4.0
    v_exp_f32 v37, v37
    v_exp_f32 v38, v38
    v_exp_f32 v39, v39
    v_exp_f32 v40, v40
    v_exp_f32 v41, v41
    v_exp_f32 v42, v42
    v_smfmac_f32_32x32x32_bf16 v[64:79], v[96:99], v[32:39], v12
    s_add_u32 s33, s56, 0x200000
    buffer_load_dwordx4 v[248:251], v1, s[8:11], s33 offen
    v_exp_f32 v43, v43
    v_exp_f32 v44, v44
    v_exp_f32 v45, v45
    v_exp_f32 v46, v46
    v_exp_f32 v47, v47
    v_exp_f32 v16, v16
    v_exp_f32 v17, v17
    v_smfmac_f32_32x32x32_bf16 v[64:79], v[100:103], v[40:47], v12
    s_add_u32 s55, s57, 0xb000
    s_and_b32 s55, s55, 0xffff
    buffer_load_dwordx4 v[120:123], v3, s[8:11], s55 offen offset:0
    s_mov_b64 exec, s[44:45]
    buffer_load_dwordx4 v[96:99], v4, s[8:11], s55 offen offset:1024
    buffer_load_dwordx4 v[100:103], v4, s[8:11], s55 offen offset:1536
    s_mov_b64 exec, -1
    v_exp_f32 v18, v18
    v_exp_f32 v19, v19
    v_exp_f32 v20, v20
    v_mfma_f32_32x32x16_bf16 v[32:47], v[124:127], v[132:135], 4.0
    v_exp_f32 v21, v21
    v_exp_f32 v22, v22
    v_exp_f32 v23, v23
    v_exp_f32 v24, v24
    v_exp_f32 v25, v25
    v_exp_f32 v26, v26
    v_smfmac_f32_32x32x32_bf16 v[48:63], v[104:107], v[16:23], v12
    s_add_u32 s33, s56, 0x200400
    buffer_load_dwordx4 v[248:251], v1, s[8:11], s33 offen
    v_exp_f32 v27, v27
    v_exp_f32 v28, v28
    v_exp_f32 v29, v29
    v_exp_f32 v30, v30
    v_exp_f32 v31, v31
    v_exp_f32 v32, v32
    v_exp_f32 v33, v33
    v_smfmac_f32_32x32x32_bf16 v[48:63], v[108:111], v[24:31], v12
    s_waitcnt vmcnt(12)
    v_exp_f32 v34, v34
    v_exp_f32 v35, v35
    v_exp_f32 v36, v36
    v_mfma_f32_32x32x16_bf16 v[16:31], v[112:115], v[128:131], 4.0
    v_exp_f32 v37, v37
    v_exp_f32 v38, v38
    v_exp_f32 v39, v39
    v_exp_f32 v40, v40
    v_exp_f32 v41, v41
    v_exp_f32 v42, v42
    v_smfmac_f32_32x32x32_bf16 v[64:79], v[104:107], v[32:39], v12
    s_add_u32 s33, s56, 0x280000
    buffer_load_dwordx4 v[248:251], v1, s[8:11], s33 offen
    v_exp_f32 v43, v43
    v_exp_f32 v44, v44
    v_exp_f32 v45, v45
    v_exp_f32 v46, v46
    v_exp_f32 v47, v47
    v_exp_f32 v16, v16
    v_exp_f32 v17, v17
    v_smfmac_f32_32x32x32_bf16 v[64:79], v[108:111], v[40:47], v12
    buffer_load_dwordx4 v[124:127], v3, s[8:11], s55 offen offset:2048
    s_mov_b64 exec, s[44:45]
    buffer_load_dwordx4 v[104:107], v4, s[8:11], s55 offen offset:3072
    buffer_load_dwordx4 v[108:111], v4, s[8:11], s55 offen offset:3584
    s_mov_b64 exec, -1
    v_exp_f32 v18, v18
    v_exp_f32 v19, v19
    v_exp_f32 v20, v20
    v_mfma_f32_32x32x16_bf16 v[32:47], v[112:115], v[132:135], 4.0
    v_exp_f32 v21, v21
    v_exp_f32 v22, v22
    v_exp_f32 v23, v23
    v_exp_f32 v24, v24
    v_exp_f32 v25, v25
    v_exp_f32 v26, v26
    v_smfmac_f32_32x32x32_bf16 v[48:63], v[80:83], v[16:23], v12
    s_add_u32 s33, s56, 0x280400
    buffer_load_dwordx4 v[248:251], v1, s[8:11], s33 offen
    v_exp_f32 v27, v27
    v_exp_f32 v28, v28
    v_exp_f32 v29, v29
    v_exp_f32 v30, v30
    v_exp_f32 v31, v31
    v_exp_f32 v32, v32
    v_exp_f32 v33, v33
    v_smfmac_f32_32x32x32_bf16 v[48:63], v[84:87], v[24:31], v12
    s_waitcnt vmcnt(12)
    v_exp_f32 v34, v34
    v_exp_f32 v35, v35
    v_exp_f32 v36, v36
    v_mfma_f32_32x32x16_bf16 v[16:31], v[116:119], v[128:131], 4.0
    v_exp_f32 v37, v37
    v_exp_f32 v38, v38
    v_exp_f32 v39, v39
    v_exp_f32 v40, v40
    v_exp_f32 v41, v41
    v_exp_f32 v42, v42
    v_smfmac_f32_32x32x32_bf16 v[64:79], v[80:83], v[32:39], v12
    s_add_u32 s31, s76, 0x0
    buffer_load_dwordx4 v[144:147], v1, s[8:11], s31 offen offset:0
    v_exp_f32 v43, v43
    v_exp_f32 v44, v44
    v_exp_f32 v45, v45
    v_exp_f32 v46, v46
    v_exp_f32 v47, v47
    v_exp_f32 v16, v16
    v_exp_f32 v17, v17
    v_smfmac_f32_32x32x32_bf16 v[64:79], v[84:87], v[40:47], v12
    s_add_u32 s55, s57, 0xc000
    s_and_b32 s55, s55, 0xffff
    buffer_load_dwordx4 v[112:115], v3, s[8:11], s55 offen offset:0
    s_mov_b64 exec, s[44:45]
    buffer_load_dwordx4 v[80:83], v4, s[8:11], s55 offen offset:1024
    buffer_load_dwordx4 v[84:87], v4, s[8:11], s55 offen offset:1536
    s_mov_b64 exec, -1
    v_exp_f32 v18, v18
    v_exp_f32 v19, v19
    v_exp_f32 v20, v20
    v_mfma_f32_32x32x16_bf16 v[32:47], v[116:119], v[132:135], 4.0
    v_exp_f32 v21, v21
    v_exp_f32 v22, v22
    v_exp_f32 v23, v23
    v_exp_f32 v24, v24
    v_exp_f32 v25, v25
    v_exp_f32 v26, v26
    v_smfmac_f32_32x32x32_bf16 v[48:63], v[88:91], v[16:23], v12
    buffer_load_dwordx4 v[148:151], v1, s[8:11], s31 offen offset:1024
    v_exp_f32 v27, v27
    v_exp_f32 v28, v28
    v_exp_f32 v29, v29
    v_exp_f32 v30, v30
    v_exp_f32 v31, v31
    v_exp_f32 v32, v32
    v_exp_f32 v33, v33
    v_smfmac_f32_32x32x32_bf16 v[48:63], v[92:95], v[24:31], v12
    s_waitcnt vmcnt(11)
    v_exp_f32 v34, v34
    v_exp_f32 v35, v35
    v_exp_f32 v36, v36
    v_mfma_f32_32x32x16_bf16 v[16:31], v[120:123], v[128:131], 4.0
    v_exp_f32 v37, v37
    v_exp_f32 v38, v38
    v_exp_f32 v39, v39
    v_exp_f32 v40, v40
    v_exp_f32 v41, v41
    v_exp_f32 v42, v42
    v_smfmac_f32_32x32x32_bf16 v[64:79], v[88:91], v[32:39], v12
    buffer_load_dwordx4 v[152:155], v1, s[8:11], s31 offen offset:2048
    v_exp_f32 v43, v43
    v_exp_f32 v44, v44
    v_exp_f32 v45, v45
    v_exp_f32 v46, v46
    v_exp_f32 v47, v47
    v_exp_f32 v16, v16
    v_exp_f32 v17, v17
    v_smfmac_f32_32x32x32_bf16 v[64:79], v[92:95], v[40:47], v12
    buffer_load_dwordx4 v[116:119], v3, s[8:11], s55 offen offset:2048
    s_mov_b64 exec, s[44:45]
    buffer_load_dwordx4 v[88:91], v4, s[8:11], s55 offen offset:3072
    buffer_load_dwordx4 v[92:95], v4, s[8:11], s55 offen offset:3584
    s_mov_b64 exec, -1
    v_exp_f32 v18, v18
    v_exp_f32 v19, v19
    v_exp_f32 v20, v20
    v_mfma_f32_32x32x16_bf16 v[32:47], v[120:123], v[132:135], 4.0
    v_exp_f32 v21, v21
    v_exp_f32 v22, v22
    v_exp_f32 v23, v23
    v_exp_f32 v24, v24
    v_exp_f32 v25, v25
    v_exp_f32 v26, v26
    v_smfmac_f32_32x32x32_bf16 v[48:63], v[96:99], v[16:23], v12
    buffer_load_dwordx4 v[156:159], v1, s[8:11], s31 offen offset:3072
    v_exp_f32 v27, v27
    v_exp_f32 v28, v28
    v_exp_f32 v29, v29
    v_exp_f32 v30, v30
    v_exp_f32 v31, v31
    v_exp_f32 v32, v32
    v_exp_f32 v33, v33
    v_smfmac_f32_32x32x32_bf16 v[48:63], v[100:103], v[24:31], v12
    s_waitcnt vmcnt(11)
    v_exp_f32 v34, v34
    v_exp_f32 v35, v35
    v_exp_f32 v36, v36
    v_mfma_f32_32x32x16_bf16 v[16:31], v[124:127], v[128:131], 4.0
    v_exp_f32 v37, v37
    v_exp_f32 v38, v38
    v_exp_f32 v39, v39
    v_exp_f32 v40, v40
    v_exp_f32 v41, v41
    v_exp_f32 v42, v42
    v_smfmac_f32_32x32x32_bf16 v[64:79], v[96:99], v[32:39], v12
    s_add_u32 s31, s76, 0x1000
    buffer_load_dwordx4 v[160:163], v1, s[8:11], s31 offen offset:0
    v_exp_f32 v43, v43
    v_exp_f32 v44, v44
    v_exp_f32 v45, v45
    v_exp_f32 v46, v46
    v_exp_f32 v47, v47
    v_exp_f32 v16, v16
    v_exp_f32 v17, v17
    v_smfmac_f32_32x32x32_bf16 v[64:79], v[100:103], v[40:47], v12
    s_add_u32 s55, s57, 0xd000
    s_and_b32 s55, s55, 0xffff
    buffer_load_dwordx4 v[120:123], v3, s[8:11], s55 offen offset:0
    s_mov_b64 exec, s[44:45]
    buffer_load_dwordx4 v[96:99], v4, s[8:11], s55 offen offset:1024
    buffer_load_dwordx4 v[100:103], v4, s[8:11], s55 offen offset:1536
    s_mov_b64 exec, -1
    v_exp_f32 v18, v18
    v_exp_f32 v19, v19
    v_exp_f32 v20, v20
    v_mfma_f32_32x32x16_bf16 v[32:47], v[124:127], v[132:135], 4.0
    v_exp_f32 v21, v21
    v_exp_f32 v22, v22
    v_exp_f32 v23, v23
    v_exp_f32 v24, v24
    v_exp_f32 v25, v25
    v_exp_f32 v26, v26
    v_smfmac_f32_32x32x32_bf16 v[48:63], v[104:107], v[16:23], v12
    buffer_load_dwordx4 v[164:167], v1, s[8:11], s31 offen offset:1024
    v_exp_f32 v27, v27
    v_exp_f32 v28, v28
    v_exp_f32 v29, v29
    v_exp_f32 v30, v30
    v_exp_f32 v31, v31
    v_exp_f32 v32, v32
    v_exp_f32 v33, v33
    v_smfmac_f32_32x32x32_bf16 v[48:63], v[108:111], v[24:31], v12
    s_waitcnt vmcnt(11)
    v_exp_f32 v34, v34
    v_exp_f32 v35, v35
    v_exp_f32 v36, v36
    v_mfma_f32_32x32x16_bf16 v[16:31], v[112:115], v[128:131], 4.0
    v_exp_f32 v37, v37
    v_exp_f32 v38, v38
    v_exp_f32 v39, v39
    v_exp_f32 v40, v40
    v_exp_f32 v41, v41
    v_exp_f32 v42, v42
    v_smfmac_f32_32x32x32_bf16 v[64:79], v[104:107], v[32:39], v12
    buffer_load_dwordx4 v[168:171], v1, s[8:11], s31 offen offset:2048
    v_exp_f32 v43, v43
    v_exp_f32 v44, v44
    v_exp_f32 v45, v45
    v_exp_f32 v46, v46
    v_exp_f32 v47, v47
    v_exp_f32 v16, v16
    v_exp_f32 v17, v17
    v_smfmac_f32_32x32x32_bf16 v[64:79], v[108:111], v[40:47], v12
    buffer_load_dwordx4 v[124:127], v3, s[8:11], s55 offen offset:2048
    s_mov_b64 exec, s[44:45]
    buffer_load_dwordx4 v[104:107], v4, s[8:11], s55 offen offset:3072
    buffer_load_dwordx4 v[108:111], v4, s[8:11], s55 offen offset:3584
    s_mov_b64 exec, -1
    v_exp_f32 v18, v18
    v_exp_f32 v19, v19
    v_exp_f32 v20, v20
    v_mfma_f32_32x32x16_bf16 v[32:47], v[112:115], v[132:135], 4.0
    v_exp_f32 v21, v21
    v_exp_f32 v22, v22
    v_exp_f32 v23, v23
    v_exp_f32 v24, v24
    v_exp_f32 v25, v25
    v_exp_f32 v26, v26
    v_smfmac_f32_32x32x32_bf16 v[48:63], v[80:83], v[16:23], v12
    buffer_load_dwordx4 v[172:175], v1, s[8:11], s31 offen offset:3072
    v_exp_f32 v27, v27
    v_exp_f32 v28, v28
    v_exp_f32 v29, v29
    v_exp_f32 v30, v30
    v_exp_f32 v31, v31
    v_exp_f32 v32, v32
    v_exp_f32 v33, v33
    v_smfmac_f32_32x32x32_bf16 v[48:63], v[84:87], v[24:31], v12
    s_waitcnt vmcnt(11)
    v_exp_f32 v34, v34
    v_exp_f32 v35, v35
    v_exp_f32 v36, v36
    v_mfma_f32_32x32x16_bf16 v[16:31], v[116:119], v[128:131], 4.0
    v_exp_f32 v37, v37
    v_exp_f32 v38, v38
    v_exp_f32 v39, v39
    v_exp_f32 v40, v40
    v_exp_f32 v41, v41
    v_exp_f32 v42, v42
    v_smfmac_f32_32x32x32_bf16 v[64:79], v[80:83], v[32:39], v12
    s_add_u32 s31, s76, 0x2000
    buffer_load_dwordx4 v[176:179], v1, s[8:11], s31 offen offset:0
    v_exp_f32 v43, v43
    v_exp_f32 v44, v44
    v_exp_f32 v45, v45
    v_exp_f32 v46, v46
    v_exp_f32 v47, v47
    v_exp_f32 v16, v16
    v_exp_f32 v17, v17
    v_smfmac_f32_32x32x32_bf16 v[64:79], v[84:87], v[40:47], v12
    s_add_u32 s55, s57, 0xe000
    s_and_b32 s55, s55, 0xffff
    buffer_load_dwordx4 v[112:115], v3, s[8:11], s55 offen offset:0
    s_mov_b64 exec, s[44:45]
    buffer_load_dwordx4 v[80:83], v4, s[8:11], s55 offen offset:1024
    buffer_load_dwordx4 v[84:87], v4, s[8:11], s55 offen offset:1536
    s_mov_b64 exec, -1
    v_exp_f32 v18, v18
    v_exp_f32 v19, v19
    v_exp_f32 v20, v20
    v_mfma_f32_32x32x16_bf16 v[32:47], v[116:119], v[132:135], 4.0
    v_exp_f32 v21, v21
    v_exp_f32 v22, v22
    v_exp_f32 v23, v23
    v_exp_f32 v24, v24
    v_exp_f32 v25, v25
    v_exp_f32 v26, v26
    v_smfmac_f32_32x32x32_bf16 v[48:63], v[88:91], v[16:23], v12
    buffer_load_dwordx4 v[180:183], v1, s[8:11], s31 offen offset:1024
    v_exp_f32 v27, v27
    v_exp_f32 v28, v28
    v_exp_f32 v29, v29
    v_exp_f32 v30, v30
    v_exp_f32 v31, v31
    v_exp_f32 v32, v32
    v_exp_f32 v33, v33
    v_smfmac_f32_32x32x32_bf16 v[48:63], v[92:95], v[24:31], v12
    s_waitcnt vmcnt(11)
    v_exp_f32 v34, v34
    v_exp_f32 v35, v35
    v_exp_f32 v36, v36
    v_mfma_f32_32x32x16_bf16 v[16:31], v[120:123], v[128:131], 4.0
    v_exp_f32 v37, v37
    v_exp_f32 v38, v38
    v_exp_f32 v39, v39
    v_exp_f32 v40, v40
    v_exp_f32 v41, v41
    v_exp_f32 v42, v42
    v_smfmac_f32_32x32x32_bf16 v[64:79], v[88:91], v[32:39], v12
    buffer_load_dwordx4 v[184:187], v1, s[8:11], s31 offen offset:2048
    v_exp_f32 v43, v43
    v_exp_f32 v44, v44
    v_exp_f32 v45, v45
    v_exp_f32 v46, v46
    v_exp_f32 v47, v47
    v_exp_f32 v16, v16
    v_exp_f32 v17, v17
    v_smfmac_f32_32x32x32_bf16 v[64:79], v[92:95], v[40:47], v12
    buffer_load_dwordx4 v[116:119], v3, s[8:11], s55 offen offset:2048
    s_mov_b64 exec, s[44:45]
    buffer_load_dwordx4 v[88:91], v4, s[8:11], s55 offen offset:3072
    buffer_load_dwordx4 v[92:95], v4, s[8:11], s55 offen offset:3584
    s_mov_b64 exec, -1
    v_exp_f32 v18, v18
    v_exp_f32 v19, v19
    v_exp_f32 v20, v20
    v_mfma_f32_32x32x16_bf16 v[32:47], v[120:123], v[132:135], 4.0
    v_exp_f32 v21, v21
    v_exp_f32 v22, v22
    v_exp_f32 v23, v23
    v_exp_f32 v24, v24
    v_exp_f32 v25, v25
    v_exp_f32 v26, v26
    v_smfmac_f32_32x32x32_bf16 v[48:63], v[96:99], v[16:23], v12
    buffer_load_dwordx4 v[188:191], v1, s[8:11], s31 offen offset:3072
    v_exp_f32 v27, v27
    v_exp_f32 v28, v28
    v_exp_f32 v29, v29
    v_exp_f32 v30, v30
    v_exp_f32 v31, v31
    v_exp_f32 v32, v32
    v_exp_f32 v33, v33
    v_smfmac_f32_32x32x32_bf16 v[48:63], v[100:103], v[24:31], v12
    s_waitcnt vmcnt(11)
    v_exp_f32 v34, v34
    v_exp_f32 v35, v35
    v_exp_f32 v36, v36
    v_mfma_f32_32x32x16_bf16 v[16:31], v[124:127], v[128:131], 4.0
    v_exp_f32 v37, v37
    v_exp_f32 v38, v38
    v_exp_f32 v39, v39
    v_exp_f32 v40, v40
    v_exp_f32 v41, v41
    v_exp_f32 v42, v42
    v_smfmac_f32_32x32x32_bf16 v[64:79], v[96:99], v[32:39], v12
    s_add_u32 s31, s76, 0x3000
    buffer_load_dwordx4 v[192:195], v1, s[8:11], s31 offen offset:0
    v_exp_f32 v43, v43
    v_exp_f32 v44, v44
    v_exp_f32 v45, v45
    v_exp_f32 v46, v46
    v_exp_f32 v47, v47
    v_exp_f32 v16, v16
    v_exp_f32 v17, v17
    v_smfmac_f32_32x32x32_bf16 v[64:79], v[100:103], v[40:47], v12
    s_add_u32 s55, s57, 0xf000
    s_and_b32 s55, s55, 0xffff
    buffer_load_dwordx4 v[120:123], v3, s[8:11], s55 offen offset:0
    s_mov_b64 exec, s[44:45]
    buffer_load_dwordx4 v[96:99], v4, s[8:11], s55 offen offset:1024
    buffer_load_dwordx4 v[100:103], v4, s[8:11], s55 offen offset:1536
    s_mov_b64 exec, -1
    v_exp_f32 v18, v18
    v_exp_f32 v19, v19
    v_exp_f32 v20, v20
    v_mfma_f32_32x32x16_bf16 v[32:47], v[124:127], v[132:135], 4.0
    v_exp_f32 v21, v21
    v_exp_f32 v22, v22
    v_exp_f32 v23, v23
    v_exp_f32 v24, v24
    v_exp_f32 v25, v25
    v_exp_f32 v26, v26
    v_smfmac_f32_32x32x32_bf16 v[48:63], v[104:107], v[16:23], v12
    buffer_load_dwordx4 v[196:199], v1, s[8:11], s31 offen offset:1024
    v_exp_f32 v27, v27
    v_exp_f32 v28, v28
    v_exp_f32 v29, v29
    v_exp_f32 v30, v30
    v_exp_f32 v31, v31
    v_exp_f32 v32, v32
    v_exp_f32 v33, v33
    v_smfmac_f32_32x32x32_bf16 v[48:63], v[108:111], v[24:31], v12
    s_waitcnt vmcnt(11)
    v_exp_f32 v34, v34
    v_exp_f32 v35, v35
    v_exp_f32 v36, v36
    v_mfma_f32_32x32x16_bf16 v[16:31], v[112:115], v[128:131], 4.0
    v_exp_f32 v37, v37
    v_exp_f32 v38, v38
    v_exp_f32 v39, v39
    v_exp_f32 v40, v40
    v_exp_f32 v41, v41
    v_exp_f32 v42, v42
    v_smfmac_f32_32x32x32_bf16 v[64:79], v[104:107], v[32:39], v12
    buffer_load_dwordx4 v[200:203], v1, s[8:11], s31 offen offset:2048
    v_exp_f32 v43, v43
    v_exp_f32 v44, v44
    v_exp_f32 v45, v45
    v_exp_f32 v46, v46
    v_exp_f32 v47, v47
    s_setprio 0
    v_exp_f32 v16, v16
    v_exp_f32 v17, v17
    v_smfmac_f32_32x32x32_bf16 v[64:79], v[108:111], v[40:47], v12
    buffer_load_dwordx4 v[124:127], v3, s[8:11], s55 offen offset:2048
    s_mov_b64 exec, s[44:45]
    buffer_load_dwordx4 v[104:107], v4, s[8:11], s55 offen offset:3072
    buffer_load_dwordx4 v[108:111], v4, s[8:11], s55 offen offset:3584
    s_mov_b64 exec, -1
    v_exp_f32 v18, v18
    v_exp_f32 v19, v19
    v_exp_f32 v20, v20
    v_mfma_f32_32x32x16_bf16 v[32:47], v[112:115], v[132:135], 4.0
    v_exp_f32 v21, v21
    v_exp_f32 v22, v22
    v_exp_f32 v23, v23
    v_exp_f32 v24, v24
    v_exp_f32 v25, v25
    v_exp_f32 v26, v26
    v_smfmac_f32_32x32x32_bf16 v[48:63], v[80:83], v[16:23], v12
    buffer_load_dwordx4 v[204:207], v1, s[8:11], s31 offen offset:3072
    v_exp_f32 v27, v27
    v_exp_f32 v28, v28
    v_exp_f32 v29, v29
    v_exp_f32 v30, v30
    v_exp_f32 v31, v31
    v_exp_f32 v32, v32
    v_exp_f32 v33, v33
    v_smfmac_f32_32x32x32_bf16 v[48:63], v[84:87], v[24:31], v12
    s_waitcnt vmcnt(11)
    v_exp_f32 v34, v34
    v_exp_f32 v35, v35
    v_exp_f32 v36, v36
    v_mfma_f32_32x32x16_bf16 v[16:31], v[116:119], v[128:131], 4.0
    v_exp_f32 v37, v37
    v_exp_f32 v38, v38
    v_exp_f32 v39, v39
    v_exp_f32 v40, v40
    v_exp_f32 v41, v41
    v_exp_f32 v42, v42
    v_smfmac_f32_32x32x32_bf16 v[64:79], v[80:83], v[32:39], v12
    v_exp_f32 v43, v43
    v_exp_f32 v44, v44
    v_exp_f32 v45, v45
    v_exp_f32 v46, v46
    v_exp_f32 v47, v47
    v_exp_f32 v16, v16
    v_exp_f32 v17, v17
    v_smfmac_f32_32x32x32_bf16 v[64:79], v[84:87], v[40:47], v12
    v_exp_f32 v18, v18
    v_exp_f32 v19, v19
    v_exp_f32 v20, v20
    v_mfma_f32_32x32x16_bf16 v[32:47], v[116:119], v[132:135], 4.0
    v_exp_f32 v21, v21
    v_exp_f32 v22, v22
    v_exp_f32 v23, v23
    v_exp_f32 v24, v24
    v_exp_f32 v25, v25
    v_exp_f32 v26, v26
    v_smfmac_f32_32x32x32_bf16 v[48:63], v[88:91], v[16:23], v12
    s_add_u32 s31, s76, 0x4000
    buffer_load_dwordx4 v[112:115], v1, s[8:11], s31 offen offset:0
    s_add_u32 s31, s76, 0x4000
    buffer_load_dwordx4 v[80:83], v1, s[8:11], s31 offen offset:1024
    s_add_u32 s31, s76, 0x4000
    buffer_load_dwordx4 v[84:87], v1, s[8:11], s31 offen offset:2048
    v_exp_f32 v27, v27
    v_exp_f32 v28, v28
    v_exp_f32 v29, v29
    v_exp_f32 v30, v30
    v_exp_f32 v31, v31
    v_exp_f32 v32, v32
    v_exp_f32 v33, v33
    v_smfmac_f32_32x32x32_bf16 v[48:63], v[92:95], v[24:31], v12
    s_waitcnt vmcnt(9)
    v_exp_f32 v34, v34
    v_exp_f32 v35, v35
    v_exp_f32 v36, v36
    v_mfma_f32_32x32x16_bf16 v[16:31], v[120:123], v[128:131], 4.0
    v_exp_f32 v37, v37
    v_exp_f32 v38, v38
    v_exp_f32 v39, v39
    v_exp_f32 v40, v40
    v_exp_f32 v41, v41
    v_exp_f32 v42, v42
    v_smfmac_f32_32x32x32_bf16 v[64:79], v[88:91], v[32:39], v12
    v_bfe_u32 v244, v2, 3, 2
    v_add_u32 v244, 1, v244
    v_sub_u32 v244, s20, v244
    v_lshlrev_b32 v244, 9, v244
    v_lshlrev_b32 v246, 2, v2
    v_and_b32 v245, 28, v246
    s_lshl_b32 s26, s21, 5
    v_add3_u32 v244, v244, v245, s26
    v_and_b32 v244, 0x7fffffff, v244
    s_lshl_b32 s26, s25, 8
    s_add_u32 s26, s26, 0x42000
    s_cmp_eq_u32 s22, 7
    s_cselect_b32 s26, s26, 0x40000000
    s_lshl_b32 s27, s20, 9
    s_add_u32 s27, s27, s26
    buffer_load_dword v212, v244, s[8:11], s26 offen sc1
    buffer_load_dword v213, v246, s[8:11], s27 offen sc1
    v_exp_f32 v43, v43
    v_exp_f32 v44, v44
    v_exp_f32 v45, v45
    v_exp_f32 v46, v46
    v_exp_f32 v47, v47
    v_exp_f32 v16, v16
    v_exp_f32 v17, v17
    v_smfmac_f32_32x32x32_bf16 v[64:79], v[92:95], v[40:47], v12
    v_exp_f32 v18, v18
    v_exp_f32 v19, v19
    v_exp_f32 v20, v20
    v_mfma_f32_32x32x16_bf16 v[32:47], v[120:123], v[132:135], 4.0
    v_exp_f32 v21, v21
    v_exp_f32 v22, v22
    v_exp_f32 v23, v23
    v_exp_f32 v24, v24
    v_exp_f32 v25, v25
    v_exp_f32 v26, v26
    v_smfmac_f32_32x32x32_bf16 v[48:63], v[96:99], v[16:23], v12
    s_add_u32 s31, s76, 0x4000
    buffer_load_dwordx4 v[116:119], v1, s[8:11], s31 offen offset:3072
    s_add_u32 s31, s76, 0x5000
    buffer_load_dwordx4 v[88:91], v1, s[8:11], s31 offen offset:0
    s_add_u32 s31, s76, 0x5000
    buffer_load_dwordx4 v[92:95], v1, s[8:11], s31 offen offset:1024
    v_exp_f32 v27, v27
    v_exp_f32 v28, v28
    v_exp_f32 v29, v29
    v_exp_f32 v30, v30
    v_exp_f32 v31, v31
    v_exp_f32 v32, v32
    v_exp_f32 v33, v33
    v_smfmac_f32_32x32x32_bf16 v[48:63], v[100:103], v[24:31], v12
    s_waitcnt vmcnt(9)
    v_exp_f32 v34, v34
    v_exp_f32 v35, v35
    v_exp_f32 v36, v36
    v_mfma_f32_32x32x16_bf16 v[16:31], v[124:127], v[128:131], 4.0
    v_exp_f32 v37, v37
    v_exp_f32 v38, v38
    v_exp_f32 v39, v39
    v_exp_f32 v40, v40
    v_exp_f32 v41, v41
    v_exp_f32 v42, v42
    v_smfmac_f32_32x32x32_bf16 v[64:79], v[96:99], v[32:39], v12
    v_exp_f32 v43, v43
    v_exp_f32 v44, v44
    v_exp_f32 v45, v45
    v_exp_f32 v46, v46
    v_exp_f32 v47, v47
    v_exp_f32 v16, v16
    v_exp_f32 v17, v17
    v_smfmac_f32_32x32x32_bf16 v[64:79], v[100:103], v[40:47], v12
    v_exp_f32 v18, v18
    v_exp_f32 v19, v19
    v_exp_f32 v20, v20
    v_mfma_f32_32x32x16_bf16 v[32:47], v[124:127], v[132:135], 4.0
    v_exp_f32 v21, v21
    v_exp_f32 v22, v22
    v_exp_f32 v23, v23
    v_exp_f32 v24, v24
    v_exp_f32 v25, v25
    v_exp_f32 v26, v26
    v_smfmac_f32_32x32x32_bf16 v[48:63], v[104:107], v[16:23], v12
    s_add_u32 s31, s76, 0x5000
    buffer_load_dwordx4 v[120:123], v1, s[8:11], s31 offen offset:2048
    s_add_u32 s31, s76, 0x5000
    buffer_load_dwordx4 v[96:99], v1, s[8:11], s31 offen offset:3072
    s_add_u32 s31, s76, 0x6000
    buffer_load_dwordx4 v[100:103], v1, s[8:11], s31 offen offset:0
    v_lshrrev_b32 v6, 2, v1
    v_sub_u32 v6, v6, v1
    v_add_u32 v7, v11, v6
    v_add_u32 v8, v10, v6
    v_exp_f32 v27, v27
    v_exp_f32 v28, v28
    v_exp_f32 v29, v29
    v_exp_f32 v30, v30
    v_exp_f32 v31, v31
    v_exp_f32 v32, v32
    v_exp_f32 v33, v33
    v_smfmac_f32_32x32x32_bf16 v[48:63], v[108:111], v[24:31], v12
    v_exp_f32 v34, v34
    v_exp_f32 v35, v35
    v_exp_f32 v36, v36
    v_exp_f32 v37, v37
    v_exp_f32 v38, v38
    v_exp_f32 v39, v39
    v_exp_f32 v40, v40
    v_exp_f32 v41, v41
    v_exp_f32 v42, v42
    v_smfmac_f32_32x32x32_bf16 v[64:79], v[104:107], v[32:39], v12
    v_exp_f32 v43, v43
    v_exp_f32 v44, v44
    v_exp_f32 v45, v45
    v_exp_f32 v46, v46
    v_exp_f32 v47, v47
    ds_write_b128 v11, v[48:51]
    ds_write_b128 v11, v[52:55] offset:1024
    ds_write_b32 v7, v56 offset:2048
    v_add_u32 v5, 1, v5
    ds_write_b32 v208, v5
    v_smfmac_f32_32x32x32_bf16 v[64:79], v[108:111], v[40:47], v12
    s_setprio 0
    s_add_u32 s31, s76, 0x6000
    buffer_load_dwordx4 v[124:127], v1, s[8:11], s31 offen offset:1024
    s_add_u32 s31, s76, 0x6000
    buffer_load_dwordx4 v[104:107], v1, s[8:11], s31 offen offset:2048
    s_add_u32 s31, s76, 0x6000
    buffer_load_dwordx4 v[108:111], v1, s[8:11], s31 offen offset:3072
    s_add_u32 s31, s76, 0x7000
    buffer_load_dwordx4 v[128:131], v1, s[8:11], s31 offen offset:0
    s_add_u32 s31, s76, 0x7000
    buffer_load_dwordx4 v[132:135], v1, s[8:11], s31 offen offset:1024
    s_add_u32 s31, s76, 0x7000
    buffer_load_dwordx4 v[136:139], v1, s[8:11], s31 offen offset:2048
    s_add_u32 s31, s76, 0x7000
    buffer_load_dwordx4 v[140:143], v1, s[8:11], s31 offen offset:3072
    ds_read_b32 v221, v209
    ds_read_b32 v56, v8 offset:2048
    ds_read_b128 v[48:51], v10
    ds_read_b128 v[52:55], v10 offset:1024
    s_waitcnt lgkmcnt(3)
pw_13:
    v_cmp_lt_u32 vcc, v221, v5
    s_nop 0
    s_and_b32 s30, vcc_lo, s75
    s_cbranch_scc1 pw_13f
pw_13o:
    s_waitcnt lgkmcnt(2)
    v_add_f32 v72, v72, v56
    v_rcp_f32 v6, v72
    v_subrev_u32 v9, 0x1f800000, v72
    v_cmp_le_u32 vcc, 0x40000000, v9
    s_waitcnt lgkmcnt(0)
    v_pk_add_f32 v[64:65], v[64:65], v[48:49]
    v_pk_add_f32 v[66:67], v[66:67], v[50:51]
    v_pk_add_f32 v[68:69], v[68:69], v[52:53]
    v_pk_add_f32 v[70:71], v[70:71], v[54:55]
    s_cbranch_vccnz aa_fb
aa_norm:
    s_add_u32 s26, s77, 0x0
    v_mov_b32 v7, v6
    v_pk_mul_f32 v[64:65], v[64:65], v[6:7]
    v_pk_mul_f32 v[66:67], v[66:67], v[6:7]
    v_pk_mul_f32 v[68:69], v[68:69], v[6:7]
    v_pk_mul_f32 v[70:71], v[70:71], v[6:7]
    v_cvt_pk_bf16_f32 v216, v64, v65
    v_cvt_pk_bf16_f32 v217, v66, v67
    v_cvt_pk_bf16_f32 v218, v68, v69
    v_cvt_pk_bf16_f32 v219, v70, v71
    s_cmp_lg_u32 s43, 0
    s_cbranch_scc0 ps_14
    buffer_store_dwordx4 v[216:219], v14, s[8:11], s26 offen
ps_15:
    s_waitcnt vmcnt(14)
fl_chk:
    v_or_b32 v9, v212, v213
    v_cmp_ne_u32 vcc, 0, v9
    s_nop 0
    s_cbranch_vccnz fl_fail
fl_ok:
    s_lshl_b32 s28, s25, 3
    s_add_u32 s28, s28, s22
    s_cmp_ge_u32 s28, 3
    s_cbranch_scc1 nocs
    s_add_u32 s28, s22, 1
    s_lshl_b32 s28, s28, 15
    s_lshl_b32 s29, s21, 12
    s_add_u32 s28, s28, s29
    s_add_u32 s28, s28, 0x1000000
    buffer_load_dwordx4 v[16:19], v1, s[8:11], s28 offen offset:0
    buffer_load_dwordx4 v[20:23], v1, s[8:11], s28 offen offset:1024
    buffer_load_dwordx4 v[24:27], v1, s[8:11], s28 offen offset:2048
    buffer_load_dwordx4 v[28:31], v1, s[8:11], s28 offen offset:3072
    v_mov_b32 v6, 1.0
    s_lshl_b32 s28, s22, 9
    s_add_u32 s28, s28, 0x26c00
    v_add_u32 v7, s28, v1
    s_waitcnt vmcnt(0)
    v_add_f32 v16, v16, v20
    v_add_f32 v24, v24, v28
    v_add_f32 v16, v16, v24
    v_add_f32 v17, v17, v21
    v_add_f32 v25, v25, v29
    v_add_f32 v17, v17, v25
    v_add_f32 v18, v18, v22
    v_add_f32 v26, v26, v30
    v_add_f32 v18, v18, v26
    v_add_f32 v19, v19, v23
    v_add_f32 v27, v27, v31
    v_add_f32 v19, v19, v27
    v_mfma_f32_16x16x4_f32 v[32:35], v6, v16, 0
    v_mfma_f32_16x16x4_f32 v[36:39], v6, v17, 0
    v_mfma_f32_16x16x4_f32 v[40:43], v6, v18, 0
    v_mfma_f32_16x16x4_f32 v[44:47], v6, v19, 0
    s_nop 15
    v_mov_b32 v33, v36
    v_mov_b32 v34, v40
    v_mov_b32 v35, v44
    s_mov_b64 exec, 0xffff
    ds_write_b128 v7, v[32:35]
    s_mov_b64 exec, -1
    s_waitcnt lgkmcnt(0)
nocs:
    s_barrier
    s_add_u32 s96, s34, 0x0
    s_add_u32 s97, s96, 0x1000
    buffer_load_dwordx4 v[16:19], v1, s[8:11], s96 offen offset:0 sc1
    buffer_load_dwordx4 v[20:23], v1, s[8:11], s96 offen offset:1024 sc1
    buffer_load_dwordx4 v[24:27], v1, s[8:11], s96 offen offset:2048 sc1
    buffer_load_dwordx4 v[28:31], v1, s[8:11], s96 offen offset:3072 sc1
    buffer_load_dwordx4 v[32:35], v1, s[8:11], s97 offen offset:0 sc1
    buffer_load_dwordx4 v[36:39], v1, s[8:11], s97 offen offset:1024 sc1
    buffer_load_dwordx4 v[40:43], v1, s[8:11], s97 offen offset:2048 sc1
    buffer_load_dwordx4 v[44:47], v1, s[8:11], s97 offen offset:3072 sc1
    v_lshlrev_b32 v48, 16, v236
    v_and_b32 v49, 0xffff0000, v236
    v_lshlrev_b32 v50, 16, v237
    v_and_b32 v51, 0xffff0000, v237
    v_lshlrev_b32 v52, 16, v238
    v_and_b32 v53, 0xffff0000, v238
    v_lshlrev_b32 v54, 16, v239
    v_and_b32 v55, 0xffff0000, v239
    s_waitcnt vmcnt(7)
    v_cmp_eq_u32_e64 s[94:95], -1, v19
    s_nop 0
    s_cmp_lg_u64 s[94:95], 0
    s_cbranch_scc1 pa_f0
pa_o0:
    v_mfma_f32_16x16x32_bf16 v[56:59], v[152:155], v[16:19], 0
    v_mfma_f32_16x16x32_bf16 v[60:63], v[156:159], v[16:19], 0
    s_waitcnt vmcnt(6)
    v_cmp_eq_u32_e64 s[94:95], -1, v23
    v_mfma_f32_16x16x32_bf16 v[48:51], v[144:147], v[16:19], v[48:51]
    v_mfma_f32_16x16x32_bf16 v[52:55], v[148:151], v[16:19], v[52:55]
    s_cmp_lg_u64 s[94:95], 0
    s_cbranch_scc1 pa_f1
pa_o1:
    v_mfma_f32_16x16x32_bf16 v[56:59], v[168:171], v[20:23], v[56:59]
    ds_read_b128 v[152:155], v211 offset:2048
    ds_read_b128 v[156:159], v211 offset:3072
    v_mfma_f32_16x16x32_bf16 v[60:63], v[172:175], v[20:23], v[60:63]
    ds_read_b128 v[144:147], v211 offset:0
    ds_read_b128 v[148:151], v211 offset:1024
    s_waitcnt vmcnt(5)
    v_cmp_eq_u32_e64 s[94:95], -1, v27
    v_mfma_f32_16x16x32_bf16 v[48:51], v[160:163], v[20:23], v[48:51]
    v_mfma_f32_16x16x32_bf16 v[52:55], v[164:167], v[20:23], v[52:55]
    s_cmp_lg_u64 s[94:95], 0
    s_cbranch_scc1 pa_f2
pa_o2:
    v_mfma_f32_16x16x32_bf16 v[56:59], v[184:187], v[24:27], v[56:59]
    ds_read_b128 v[168:171], v211 offset:6144
    ds_read_b128 v[172:175], v211 offset:7168
    v_mfma_f32_16x16x32_bf16 v[60:63], v[188:191], v[24:27], v[60:63]
    ds_read_b128 v[160:163], v211 offset:4096
    ds_read_b128 v[164:167], v211 offset:5120
    s_waitcnt vmcnt(4)
    v_cmp_eq_u32_e64 s[94:95], -1, v31
    v_mfma_f32_16x16x32_bf16 v[48:51], v[176:179], v[24:27], v[48:51]
    v_mfma_f32_16x16x32_bf16 v[52:55], v[180:183], v[24:27], v[52:55]
    s_cmp_lg_u64 s[94:95], 0
    s_cbranch_scc1 pa_f3
pa_o3:
    v_mfma_f32_16x16x32_bf16 v[56:59], v[200:203], v[28:31], v[56:59]
    ds_read_b128 v[184:187], v211 offset:10240
    ds_read_b128 v[188:191], v211 offset:11264
    v_mfma_f32_16x16x32_bf16 v[60:63], v[204:207], v[28:31], v[60:63]
    ds_read_b128 v[176:179], v211 offset:8192
    ds_read_b128 v[180:183], v211 offset:9216
    s_waitcnt vmcnt(3)
    v_cmp_eq_u32_e64 s[94:95], -1, v35
    v_mfma_f32_16x16x32_bf16 v[48:51], v[192:195], v[28:31], v[48:51]
    v_mfma_f32_16x16x32_bf16 v[52:55], v[196:199], v[28:31], v[52:55]
    s_cmp_lg_u64 s[94:95], 0
    s_cbranch_scc1 pa_f4
pa_o4:
    v_mfma_f32_16x16x32_bf16 v[56:59], v[84:87], v[32:35], v[56:59]
    ds_read_b128 v[200:203], v211 offset:14336
    ds_read_b128 v[204:207], v211 offset:15360
    v_mfma_f32_16x16x32_bf16 v[60:63], v[116:119], v[32:35], v[60:63]
    ds_read_b128 v[192:195], v211 offset:12288
    ds_read_b128 v[196:199], v211 offset:13312
    s_waitcnt vmcnt(2)
    v_cmp_eq_u32_e64 s[94:95], -1, v39
    v_mfma_f32_16x16x32_bf16 v[48:51], v[112:115], v[32:35], v[48:51]
    v_mfma_f32_16x16x32_bf16 v[52:55], v[80:83], v[32:35], v[52:55]
    s_cmp_lg_u64 s[94:95], 0
    s_cbranch_scc1 pa_f5
pa_o5:
    s_waitcnt vmcnt(1)
    v_cmp_eq_u32_e64 s[94:95], -1, v43
    v_mfma_f32_16x16x32_bf16 v[56:59], v[120:123], v[36:39], v[56:59]
    ds_read_b128 v[84:87], v211 offset:18432
    ds_read_b128 v[116:119], v211 offset:19456
    v_mfma_f32_16x16x32_bf16 v[60:63], v[96:99], v[36:39], v[60:63]
    ds_read_b128 v[112:115], v211 offset:16384
    ds_read_b128 v[80:83], v211 offset:17408
    s_cmp_lg_u64 s[94:95], 0
    s_cbranch_scc1 pa_f6
pa_o6:
    s_waitcnt vmcnt(0)
    v_cmp_eq_u32_e64 s[94:95], -1, v47
    v_mfma_f32_16x16x32_bf16 v[56:59], v[104:107], v[40:43], v[56:59]
    v_mfma_f32_16x16x32_bf16 v[60:63], v[108:111], v[40:43], v[60:63]
    s_cmp_lg_u64 s[94:95], 0
    s_cbranch_scc1 pa_f7
pa_o7:
    v_mfma_f32_16x16x32_bf16 v[56:59], v[136:139], v[44:47], v[56:59]
    v_mfma_f32_16x16x32_bf16 v[60:63], v[140:143], v[44:47], v[60:63]
    v_mfma_f32_16x16x32_bf16 v[48:51], v[88:91], v[36:39], v[48:51]
    v_mfma_f32_16x16x32_bf16 v[52:55], v[92:95], v[36:39], v[52:55]
    v_mfma_f32_16x16x32_bf16 v[48:51], v[100:103], v[40:43], v[48:51]
    s_nop 3
    ds_write_b128 v10, v[56:59]
    ds_write_b128 v10, v[60:63] offset:1024
    v_add_u32 v5, 1, v5
    ds_write_b32 v208, v5
    v_mfma_f32_16x16x32_bf16 v[52:55], v[124:127], v[40:43], v[52:55]
    v_mfma_f32_16x16x32_bf16 v[48:51], v[128:131], v[44:47], v[48:51]
    v_mfma_f32_16x16x32_bf16 v[52:55], v[132:135], v[44:47], v[52:55]
    ds_read_b32 v221, v209
    ds_read_b128 v[64:67], v11
    ds_read_b128 v[68:71], v11 offset:1024
    ds_read_b128 v[120:123], v211 offset:22528
    ds_read_b128 v[96:99], v211 offset:23552
    ds_read_b128 v[88:91], v211 offset:20480
    ds_read_b128 v[92:95], v211 offset:21504
    ds_read_b128 v[104:107], v211 offset:26624
    ds_read_b128 v[108:111], v211 offset:27648
    ds_read_b128 v[100:103], v211 offset:24576
    ds_read_b128 v[124:127], v211 offset:25600
    ds_read_b128 v[136:139], v211 offset:30720
    ds_read_b128 v[140:143], v211 offset:31744
    ds_read_b128 v[128:131], v211 offset:28672
    ds_read_b128 v[132:135], v211 offset:29696
    s_waitcnt lgkmcnt(14)
pw_16:
    v_cmp_lt_u32 vcc, v221, v5
    s_nop 0
    s_and_b32 s30, vcc_lo, s75
    s_cbranch_scc1 pw_16f
pw_16o:
    s_waitcnt lgkmcnt(12)
    v_pk_add_f32 v[48:49], v[48:49], v[64:65]
    v_pk_add_f32 v[50:51], v[50:51], v[66:67]
    v_pk_add_f32 v[52:53], v[52:53], v[68:69]
    v_pk_add_f32 v[54:55], v[54:55], v[70:71]
    v_cvt_pk_bf16_f32 v236, v48, v49
    v_cvt_pk_bf16_f32 v237, v50, v51
    v_cvt_pk_bf16_f32 v238, v52, v53
    v_cvt_pk_bf16_f32 v239, v54, v55
    s_add_u32 s26, s35, 0x10000
    s_cmp_lg_u32 s43, 0
    s_cbranch_scc0 ps_17
    buffer_store_dwordx4 v[236:239], v1, s[8:11], s26 offen
ps_18:
    s_waitcnt lgkmcnt(0)
    s_barrier
    s_add_u32 s96, s34, 0x10000
    s_add_u32 s97, s96, 0x1000
    buffer_load_dwordx4 v[16:19], v1, s[8:11], s96 offen offset:0 sc1
    buffer_load_dwordx4 v[20:23], v1, s[8:11], s96 offen offset:1024 sc1
    buffer_load_dwordx4 v[24:27], v1, s[8:11], s96 offen offset:2048 sc1
    buffer_load_dwordx4 v[28:31], v1, s[8:11], s96 offen offset:3072 sc1
    buffer_load_dwordx4 v[32:35], v1, s[8:11], s97 offen offset:0 sc1
    buffer_load_dwordx4 v[36:39], v1, s[8:11], s97 offen offset:1024 sc1
    buffer_load_dwordx4 v[40:43], v1, s[8:11], s97 offen offset:2048 sc1
    buffer_load_dwordx4 v[44:47], v1, s[8:11], s97 offen offset:3072 sc1
    s_setprio 3
    s_waitcnt vmcnt(7)
    v_cmp_eq_u32_e64 s[94:95], -1, v19
    s_nop 0
    s_cmp_lg_u64 s[94:95], 0
    s_cbranch_scc1 qb_f0
qb_o0:
    v_mfma_f32_16x16x32_bf16 v[216:219], v[16:19], v[16:19], 0
    v_mfma_f32_16x16x32_bf16 v[240:243], v[232:235], v[16:19], 0
    v_mfma_f32_16x16x32_bf16 v[56:59], v[152:155], v[16:19], 0
    v_mfma_f32_16x16x32_bf16 v[60:63], v[156:159], v[16:19], 0
    s_waitcnt vmcnt(6)
    v_cmp_eq_u32_e64 s[94:95], -1, v23
    v_mfma_f32_16x16x32_bf16 v[48:51], v[144:147], v[16:19], 0
    v_mfma_f32_16x16x32_bf16 v[52:55], v[148:151], v[16:19], 0
    s_cmp_lg_u64 s[94:95], 0
    s_cbranch_scc1 qb_f1
qb_o1:
    v_mfma_f32_16x16x32_bf16 v[216:219], v[20:23], v[20:23], v[216:219]
    ds_read_b128 v[152:155], v211 offset:34816
    ds_read_b128 v[156:159], v211 offset:35840
    v_mfma_f32_16x16x32_bf16 v[240:243], v[232:235], v[20:23], v[240:243]
    ds_read_b128 v[144:147], v211 offset:32768
    ds_read_b128 v[148:151], v211 offset:33792
    v_mfma_f32_16x16x32_bf16 v[56:59], v[168:171], v[20:23], v[56:59]
    v_mfma_f32_16x16x32_bf16 v[60:63], v[172:175], v[20:23], v[60:63]
    s_waitcnt vmcnt(5)
    v_cmp_eq_u32_e64 s[94:95], -1, v27
    v_mfma_f32_16x16x32_bf16 v[48:51], v[160:163], v[20:23], v[48:51]
    v_mfma_f32_16x16x32_bf16 v[52:55], v[164:167], v[20:23], v[52:55]
    s_cmp_lg_u64 s[94:95], 0
    s_cbranch_scc1 qb_f2
qb_o2:
    v_mfma_f32_16x16x32_bf16 v[216:219], v[24:27], v[24:27], v[216:219]
    ds_read_b128 v[168:171], v211 offset:38912
    ds_read_b128 v[172:175], v211 offset:39936
    v_mfma_f32_16x16x32_bf16 v[240:243], v[232:235], v[24:27], v[240:243]
    ds_read_b128 v[160:163], v211 offset:36864
    ds_read_b128 v[164:167], v211 offset:37888
    v_mfma_f32_16x16x32_bf16 v[56:59], v[184:187], v[24:27], v[56:59]
    s_add_u32 m0, s41, 0x0
    s_add_u32 s33, s39, 0x180000
    buffer_load_dwordx4 v1, s[8:11], s33 offen offset:0 lds
    buffer_load_dwordx4 v1, s[8:11], s33 offen offset:1024 lds
    v_mfma_f32_16x16x32_bf16 v[60:63], v[188:191], v[24:27], v[60:63]
    s_waitcnt vmcnt(6)
    v_cmp_eq_u32_e64 s[94:95], -1, v31
    v_mfma_f32_16x16x32_bf16 v[48:51], v[176:179], v[24:27], v[48:51]
    v_mfma_f32_16x16x32_bf16 v[52:55], v[180:183], v[24:27], v[52:55]
    s_cmp_lg_u64 s[94:95], 0
    s_cbranch_scc1 qb_f3
qb_o3:
    v_mfma_f32_16x16x32_bf16 v[216:219], v[28:31], v[28:31], v[216:219]
    ds_read_b128 v[184:187], v211 offset:43008
    ds_read_b128 v[188:191], v211 offset:44032
    v_mfma_f32_16x16x32_bf16 v[240:243], v[232:235], v[28:31], v[240:243]
    ds_read_b128 v[176:179], v211 offset:40960
    ds_read_b128 v[180:183], v211 offset:41984
    v_mfma_f32_16x16x32_bf16 v[56:59], v[200:203], v[28:31], v[56:59]
    s_add_u32 m0, s41, 0x0
    s_add_u32 s33, s39, 0x180000
    buffer_load_dwordx4 v1, s[8:11], s33 offen offset:2048 lds
    buffer_load_dwordx4 v1, s[8:11], s33 offen offset:3072 lds
    v_mfma_f32_16x16x32_bf16 v[60:63], v[204:207], v[28:31], v[60:63]
    s_waitcnt vmcnt(7)
    v_cmp_eq_u32_e64 s[94:95], -1, v35
    v_mfma_f32_16x16x32_bf16 v[48:51], v[192:195], v[28:31], v[48:51]
    v_mfma_f32_16x16x32_bf16 v[52:55], v[196:199], v[28:31], v[52:55]
    s_cmp_lg_u64 s[94:95], 0
    s_cbranch_scc1 qb_f4
qb_o4:
    v_mfma_f32_16x16x32_bf16 v[216:219], v[32:35], v[32:35], v[216:219]
    ds_read_b128 v[200:203], v211 offset:47104
    ds_read_b128 v[204:207], v211 offset:48128
    v_mfma_f32_16x16x32_bf16 v[240:243], v[232:235], v[32:35], v[240:243]
    ds_read_b128 v[192:195], v211 offset:45056
    ds_read_b128 v[196:199], v211 offset:46080
    v_mfma_f32_16x16x32_bf16 v[56:59], v[84:87], v[32:35], v[56:59]
    s_add_u32 m0, s41, 0x1000
    s_add_u32 s33, s39, 0x181000
    buffer_load_dwordx4 v1, s[8:11], s33 offen offset:0 lds
    buffer_load_dwordx4 v1, s[8:11], s33 offen offset:1024 lds
    v_mfma_f32_16x16x32_bf16 v[60:63], v[116:119], v[32:35], v[60:63]
    s_waitcnt vmcnt(8)
    v_cmp_eq_u32_e64 s[94:95], -1, v39
    v_mfma_f32_16x16x32_bf16 v[48:51], v[112:115], v[32:35], v[48:51]
    v_mfma_f32_16x16x32_bf16 v[52:55], v[80:83], v[32:35], v[52:55]
    s_cmp_lg_u64 s[94:95], 0
    s_cbranch_scc1 qb_f5
qb_o5:
    v_mfma_f32_16x16x32_bf16 v[216:219], v[36:39], v[36:39], v[216:219]
    ds_read_b128 v[84:87], v211 offset:51200
    ds_read_b128 v[116:119], v211 offset:52224
    v_mfma_f32_16x16x32_bf16 v[240:243], v[232:235], v[36:39], v[240:243]
    ds_read_b128 v[112:115], v211 offset:49152
    ds_read_b128 v[80:83], v211 offset:50176
    v_mfma_f32_16x16x32_bf16 v[56:59], v[120:123], v[36:39], v[56:59]
    s_add_u32 m0, s41, 0x1000
    s_add_u32 s33, s39, 0x181000
    buffer_load_dwordx4 v1, s[8:11], s33 offen offset:2048 lds
    buffer_load_dwordx4 v1, s[8:11], s33 offen offset:3072 lds
    v_mfma_f32_16x16x32_bf16 v[60:63], v[96:99], v[36:39], v[60:63]
    s_waitcnt vmcnt(9)
    v_cmp_eq_u32_e64 s[94:95], -1, v43
    v_mfma_f32_16x16x32_bf16 v[48:51], v[88:91], v[36:39], v[48:51]
    v_mfma_f32_16x16x32_bf16 v[52:55], v[92:95], v[36:39], v[52:55]
    s_cmp_lg_u64 s[94:95], 0
    s_cbranch_scc1 qb_f6
qb_o6:
    v_mfma_f32_16x16x32_bf16 v[216:219], v[40:43], v[40:43], v[216:219]
    ds_read_b128 v[120:123], v211 offset:55296
    ds_read_b128 v[96:99], v211 offset:56320
    v_mfma_f32_16x16x32_bf16 v[240:243], v[232:235], v[40:43], v[240:243]
    ds_read_b128 v[88:91], v211 offset:53248
    ds_read_b128 v[92:95], v211 offset:54272
    v_mfma_f32_16x16x32_bf16 v[56:59], v[104:107], v[40:43], v[56:59]
    v_mfma_f32_16x16x32_bf16 v[60:63], v[108:111], v[40:43], v[60:63]
    s_waitcnt vmcnt(8)
    v_cmp_eq_u32_e64 s[94:95], -1, v47
    v_mfma_f32_16x16x32_bf16 v[48:51], v[100:103], v[40:43], v[48:51]
    v_mfma_f32_16x16x32_bf16 v[52:55], v[124:127], v[40:43], v[52:55]
    s_cmp_lg_u64 s[94:95], 0
    s_cbranch_scc1 qb_f7
qb_o7:
    v_mfma_f32_16x16x32_bf16 v[216:219], v[44:47], v[44:47], v[216:219]
    ds_read_b128 v[104:107], v211 offset:59392
    ds_read_b128 v[108:111], v211 offset:60416
    v_mfma_f32_16x16x32_bf16 v[240:243], v[232:235], v[44:47], v[240:243]
    ds_read_b128 v[100:103], v211 offset:57344
    ds_read_b128 v[124:127], v211 offset:58368
    v_mfma_f32_16x16x32_bf16 v[56:59], v[136:139], v[44:47], v[56:59]
    v_mfma_f32_16x16x32_bf16 v[60:63], v[140:143], v[44:47], v[60:63]
    v_mfma_f32_16x16x32_bf16 v[48:51], v[128:131], v[44:47], v[48:51]
    v_mfma_f32_16x16x32_bf16 v[52:55], v[132:135], v[44:47], v[52:55]
    s_setprio 2
    s_waitcnt lgkmcnt(14)
    v_mfma_f32_16x16x32_bf16 v[72:75], v[16:19], v[152:155], 0
    ds_read_b128 v[136:139], v211 offset:63488
    ds_read_b128 v[140:143], v211 offset:64512
    v_mfma_f32_16x16x32_bf16 v[76:79], v[16:19], v[156:159], 0
    ds_read_b128 v[128:131], v211 offset:61440
    ds_read_b128 v[132:135], v211 offset:62464
    v_mfma_f32_16x16x32_bf16 v[64:67], v[16:19], v[144:147], 0
    v_mfma_f32_16x16x32_bf16 v[68:71], v[16:19], v[148:151], 0
    v_mfma_f32_16x16x32_bf16 v[72:75], v[20:23], v[168:171], v[72:75]
    v_cndmask_b32_e64 v6, v216, v217, s[88:89]
    v_cndmask_b32_e64 v7, v218, v219, s[88:89]
    v_mfma_f32_16x16x32_bf16 v[76:79], v[20:23], v[172:175], v[76:79]
    v_cndmask_b32_e64 v241, v6, v7, s[90:91]
    s_mov_b64 exec, s[92:93]
    ds_write_b64 v226, v[240:241]
    s_mov_b64 exec, -1
    v_mfma_f32_16x16x32_bf16 v[64:67], v[20:23], v[160:163], v[64:67]
    ds_write_b128 v11, v[56:59]
    ds_write_b128 v11, v[60:63] offset:1024
    v_mfma_f32_16x16x32_bf16 v[68:71], v[20:23], v[164:167], v[68:71]
    v_add_u32 v5, 1, v5
    ds_write_b32 v208, v5
    v_mfma_f32_16x16x32_bf16 v[72:75], v[24:27], v[184:187], v[72:75]
    ds_read_b32 v221, v209
    ds_read_b128 v[244:247], v227
    v_mfma_f32_16x16x32_bf16 v[76:79], v[24:27], v[188:191], v[76:79]
    ds_read_b128 v[248:251], v10
    ds_read_b128 v[252:255], v10 offset:1024
    v_mfma_f32_16x16x32_bf16 v[64:67], v[24:27], v[176:179], v[64:67]
    ds_read_b128 v[144:147], v228 offset:0
    ds_read_b128 v[148:151], v228 offset:16
    v_mfma_f32_16x16x32_bf16 v[68:71], v[24:27], v[180:183], v[68:71]
    ds_read_b128 v[152:155], v228 offset:32
    ds_read_b128 v[156:159], v228 offset:48
    s_waitcnt lgkmcnt(14)
    v_mfma_f32_16x16x32_bf16 v[72:75], v[28:31], v[200:203], v[72:75]
    ds_read_b128 v[160:163], v229 offset:0
    ds_read_b128 v[164:167], v229 offset:64
    v_mfma_f32_16x16x32_bf16 v[76:79], v[28:31], v[204:207], v[76:79]
    ds_read_b32 v168, v230 offset:512
    ds_read_b32 v169, v230 offset:512
    v_mfma_f32_16x16x32_bf16 v[64:67], v[28:31], v[192:195], v[64:67]
    ds_read_b32 v170, v230 offset:576
    ds_read_b32 v171, v230 offset:576
    v_mfma_f32_16x16x32_bf16 v[68:71], v[28:31], v[196:199], v[68:71]
    s_waitcnt lgkmcnt(13)
pw_19:
    v_cmp_lt_u32 vcc, v221, v5
    s_nop 0
    s_and_b32 s30, vcc_lo, s75
    s_cbranch_scc1 pw_19f
pw_19o:
    v_mfma_f32_16x16x32_bf16 v[72:75], v[32:35], v[84:87], v[72:75]
    s_waitcnt lgkmcnt(12)
    v_add_f32 v244, v244, v246
    v_add_f32 v245, v245, v247
    v_mul_f32 v244, 0xbb000000, v244
    v_mfma_f32_16x16x32_bf16 v[76:79], v[32:35], v[116:119], v[76:79]
    v_mul_f32 v245, 0x3b000000, v245
    v_fma_f32 v245, -v244, v244, v245
    v_max_f32 v245, 0, v245
    v_mfma_f32_16x16x32_bf16 v[72:75], v[36:39], v[120:123], v[72:75]
    v_add_f32 v245, 0x3727c5ac, v245
    v_rsq_f32 v214, v245
    s_nop 0
    v_mul_f32 v212, v244, v214
    v_mfma_f32_16x16x32_bf16 v[76:79], v[36:39], v[96:99], v[76:79]
    s_waitcnt lgkmcnt(4)
    v_add_f32 v48, v48, v248
    v_add_f32 v49, v49, v249
    v_add_f32 v50, v50, v250
    v_mfma_f32_16x16x32_bf16 v[72:75], v[40:43], v[104:107], v[72:75]
    v_add_f32 v51, v51, v251
    v_add_f32 v52, v52, v252
    v_add_f32 v53, v53, v253
    v_mfma_f32_16x16x32_bf16 v[76:79], v[40:43], v[108:111], v[76:79]
    v_add_f32 v54, v54, v254
    v_add_f32 v55, v55, v255
    v_mul_f32 v48, v214, v48
    v_mfma_f32_16x16x32_bf16 v[72:75], v[44:47], v[136:139], v[72:75]
    v_mul_f32 v49, v214, v49
    v_mul_f32 v50, v214, v50
    v_mul_f32 v51, v214, v51
    v_mfma_f32_16x16x32_bf16 v[76:79], v[44:47], v[140:143], v[76:79]
    v_mul_f32 v52, v214, v52
    v_mul_f32 v53, v214, v53
    v_mul_f32 v54, v214, v54
    v_mfma_f32_16x16x32_bf16 v[64:67], v[32:35], v[112:115], v[64:67]
    v_mul_f32 v55, v214, v55
    v_fmac_f32 v48, v212, v160
    v_fmac_f32 v49, v212, v161
    v_mfma_f32_16x16x32_bf16 v[68:71], v[32:35], v[80:83], v[68:71]
    v_fmac_f32 v50, v212, v162
    v_fmac_f32 v51, v212, v163
    v_fmac_f32 v52, v212, v164
    ds_write_b128 v10, v[72:75]
    ds_write_b128 v10, v[76:79] offset:1024
    s_waitcnt vmcnt(0)
    v_add_u32 v5, 1, v5
    ds_write_b32 v208, v5
    v_mfma_f32_16x16x32_bf16 v[64:67], v[36:39], v[88:91], v[64:67]
    v_fmac_f32 v53, v212, v165
    v_fmac_f32 v54, v212, v166
    v_fmac_f32 v55, v212, v167
    v_mfma_f32_16x16x32_bf16 v[68:71], v[36:39], v[92:95], v[68:71]
    v_cvt_pk_bf16_f32 v172, v48, v49
    v_cvt_pk_bf16_f32 v173, v50, v51
    v_cvt_pk_bf16_f32 v174, v52, v53
    v_mfma_f32_16x16x32_bf16 v[64:67], v[40:43], v[100:103], v[64:67]
    v_cvt_pk_bf16_f32 v175, v54, v55
    buffer_store_dwordx4 v[172:175], v223, s[8:11], s37 offen sc1
    v_add_f32 v144, v144, v146
    v_mfma_f32_16x16x32_bf16 v[68:71], v[40:43], v[124:127], v[68:71]
    v_add_f32 v148, v148, v150
    v_add_f32 v152, v152, v154
    v_add_f32 v156, v156, v158
    v_mfma_f32_16x16x32_bf16 v[64:67], v[44:47], v[128:131], v[64:67]
    v_add_f32 v145, v145, v147
    v_add_f32 v149, v149, v151
    v_add_f32 v153, v153, v155
    v_mfma_f32_16x16x32_bf16 v[68:71], v[44:47], v[132:135], v[68:71]
    v_add_f32 v157, v157, v159
    v_mul_f32 v144, 0xbb000000, v144
    v_mul_f32 v148, 0xbb000000, v148
    ds_read_b32 v221, v209
    ds_read_b128 v[176:179], v11
    ds_read_b128 v[180:183], v11 offset:1024
    v_mul_f32 v152, 0xbb000000, v152
    v_mul_f32 v156, 0xbb000000, v156
    v_mul_f32 v145, 0x3b000000, v145
    v_mul_f32 v149, 0x3b000000, v149
    v_mul_f32 v153, 0x3b000000, v153
    v_mul_f32 v157, 0x3b000000, v157
    v_fma_f32 v145, -v144, v144, v145
    v_fma_f32 v149, -v148, v148, v149
    v_fma_f32 v153, -v152, v152, v153
    v_fma_f32 v157, -v156, v156, v157
    v_max_f32 v145, 0, v145
    v_max_f32 v149, 0, v149
    v_max_f32 v153, 0, v153
    v_max_f32 v157, 0, v157
    v_add_f32 v145, 0x3727c5ac, v145
    v_add_f32 v149, 0x3727c5ac, v149
    v_add_f32 v153, 0x3727c5ac, v153
    v_add_f32 v157, 0x3727c5ac, v157
    v_rsq_f32 v216, v145
    v_rsq_f32 v217, v149
    v_rsq_f32 v218, v153
    v_rsq_f32 v219, v157
    v_mul_f32 v240, v144, v216
    v_mul_f32 v241, v148, v217
    v_mul_f32 v242, v152, v218
    v_mul_f32 v243, v156, v219
    s_waitcnt lgkmcnt(2)
pw_20:
    v_cmp_lt_u32 vcc, v221, v5
    s_nop 0
    s_and_b32 s30, vcc_lo, s75
    s_cbranch_scc1 pw_20f
pw_20o:
    s_waitcnt lgkmcnt(0)
    v_pk_add_f32 v[64:65], v[64:65], v[176:177]
    v_pk_add_f32 v[66:67], v[66:67], v[178:179]
    v_pk_add_f32 v[68:69], v[68:69], v[180:181]
    v_pk_add_f32 v[70:71], v[70:71], v[182:183]
    v_pk_mul_f32 v[64:65], v[64:65], v[216:217]
    v_pk_mul_f32 v[66:67], v[66:67], v[218:219]
    v_pk_mul_f32 v[68:69], v[68:69], v[216:217]
    v_pk_mul_f32 v[70:71], v[70:71], v[218:219]
    v_pk_fma_f32 v[64:65], v[240:241], v[168:169], v[64:65]
    v_pk_fma_f32 v[66:67], v[242:243], v[168:169], v[66:67]
    v_pk_fma_f32 v[68:69], v[240:241], v[170:171], v[68:69]
    v_pk_fma_f32 v[70:71], v[242:243], v[170:171], v[70:71]
    v_cvt_pk_bf16_f32 v72, v64, v65
    v_cvt_pk_bf16_f32 v74, v68, v69
    v_cvt_pk_bf16_f32 v73, v66, v67
    v_cvt_pk_bf16_f32 v75, v70, v71
    v_permlane16_swap_b32 v72, v74
    s_nop 0
    v_permlane16_swap_b32 v73, v75
    buffer_store_dwordx4 v[72:75], v224, s[8:11], s37 offen sc1
    s_setprio 0
    ds_read_b32 v221, v209
    s_waitcnt lgkmcnt(0)
pw_21:
    v_cmp_lt_u32 vcc, v221, v5
    s_nop 0
    s_and_b32 s30, vcc_lo, 0xff
    s_cbranch_scc1 pw_21f
pw_21o:
    ds_read_b128 v[184:187], v211 offset:2048
    ds_read_b128 v[188:191], v211 offset:3072
    ds_read_b128 v[176:179], v211 offset:0
    ds_read_b128 v[180:183], v211 offset:1024
    ds_read_b128 v[200:203], v211 offset:6144
    ds_read_b128 v[204:207], v211 offset:7168
    ds_read_b128 v[192:195], v211 offset:4096
    ds_read_b128 v[196:199], v211 offset:5120
    ds_read_b128 v[152:155], v211 offset:10240
    ds_read_b128 v[156:159], v211 offset:11264
    ds_read_b128 v[144:147], v211 offset:8192
    ds_read_b128 v[148:151], v211 offset:9216
    ds_read_b128 v[168:171], v211 offset:14336
    ds_read_b128 v[172:175], v211 offset:15360
    ds_read_b128 v[160:163], v211 offset:12288
    ds_read_b128 v[164:167], v211 offset:13312
    s_waitcnt lgkmcnt(12)
    v_mfma_f32_16x16x32_bf16 v[56:59], v[184:187], v[16:19], 0
    v_mul_f32 v215, 0x3eb8aa3b, v214
    v_mul_f32 v213, 0x3eb8aa3b, v212
    v_mov_b32 v214, v215
    v_mfma_f32_16x16x32_bf16 v[60:63], v[188:191], v[16:19], 0
    v_mov_b32 v212, v213
    v_and_b32 v80, s68, v15
    v_and_b32 v81, s68, v15
    v_mfma_f32_16x16x32_bf16 v[48:51], v[176:179], v[16:19], 0
    v_mov_b64 v[82:83], v[80:81]
    v_mov_b64 v[84:85], v[80:81]
    v_mov_b64 v[86:87], v[80:81]
    v_mfma_f32_16x16x32_bf16 v[52:55], v[180:183], v[16:19], 0
    v_and_b32 v88, s69, v15
    v_and_b32 v89, s69, v15
    v_mov_b64 v[90:91], v[88:89]
    s_waitcnt lgkmcnt(8)
    v_mfma_f32_16x16x32_bf16 v[56:59], v[200:203], v[20:23], v[56:59]
    ds_read_b128 v[184:187], v211 offset:18432
    ds_read_b128 v[188:191], v211 offset:19456
    ds_read_b128 v[176:179], v211 offset:16384
    v_mfma_f32_16x16x32_bf16 v[60:63], v[204:207], v[20:23], v[60:63]
    ds_read_b128 v[180:183], v211 offset:17408
    v_mov_b64 v[92:93], v[88:89]
    v_mov_b64 v[94:95], v[88:89]
    v_mfma_f32_16x16x32_bf16 v[48:51], v[192:195], v[20:23], v[48:51]
    v_and_b32 v96, s70, v15
    v_and_b32 v97, s70, v15
    v_mov_b64 v[98:99], v[96:97]
    v_mfma_f32_16x16x32_bf16 v[52:55], v[196:199], v[20:23], v[52:55]
    v_mov_b64 v[100:101], v[96:97]
    v_mov_b64 v[102:103], v[96:97]
    v_and_b32 v104, s71, v15
    s_waitcnt lgkmcnt(8)
    v_mfma_f32_16x16x32_bf16 v[56:59], v[152:155], v[24:27], v[56:59]
    ds_read_b128 v[200:203], v211 offset:22528
    ds_read_b128 v[204:207], v211 offset:23552
    ds_read_b128 v[192:195], v211 offset:20480
    v_mfma_f32_16x16x32_bf16 v[60:63], v[156:159], v[24:27], v[60:63]
    ds_read_b128 v[196:199], v211 offset:21504
    v_and_b32 v105, s71, v15
    v_mov_b64 v[106:107], v[104:105]
    v_mfma_f32_16x16x32_bf16 v[48:51], v[144:147], v[24:27], v[48:51]
    v_mov_b64 v[108:109], v[104:105]
    v_mov_b64 v[110:111], v[104:105]
    v_and_b32 v112, s72, v15
    v_mfma_f32_16x16x32_bf16 v[52:55], v[148:151], v[24:27], v[52:55]
    v_and_b32 v113, s72, v15
    v_mov_b64 v[114:115], v[112:113]
    v_mov_b64 v[116:117], v[112:113]
    s_waitcnt lgkmcnt(8)
    v_mfma_f32_16x16x32_bf16 v[56:59], v[168:171], v[28:31], v[56:59]
    ds_read_b128 v[152:155], v211 offset:26624
    ds_read_b128 v[156:159], v211 offset:27648
    ds_read_b128 v[144:147], v211 offset:24576
    v_mfma_f32_16x16x32_bf16 v[60:63], v[172:175], v[28:31], v[60:63]
    ds_read_b128 v[148:151], v211 offset:25600
    v_mov_b64 v[118:119], v[112:113]
    v_and_b32 v6, 31, v2
    v_mfma_f32_16x16x32_bf16 v[48:51], v[160:163], v[28:31], v[48:51]
    v_lshrrev_b32 v7, 5, v2
    v_lshlrev_b32 v7, 2, v7
    v_sub_u32 v6, v6, v7
    v_mfma_f32_16x16x32_bf16 v[52:55], v[164:167], v[28:31], v[52:55]
    s_cmp_eq_u32 s24, 0
    s_cselect_b32 s28, 0xceabfb8f, 0
    s_cselect_b32 s29, 0, 0xceabfb8f
    s_waitcnt lgkmcnt(8)
    v_mfma_f32_16x16x32_bf16 v[56:59], v[184:187], v[32:35], v[56:59]
    ds_read_b128 v[168:171], v211 offset:30720
    ds_read_b128 v[172:175], v211 offset:31744
    ds_read_b128 v[160:163], v211 offset:28672
    v_mfma_f32_16x16x32_bf16 v[60:63], v[188:191], v[32:35], v[60:63]
    ds_read_b128 v[164:167], v211 offset:29696
    v_mov_b32 v7, s28
    v_mov_b32 v8, s29
    s_waitcnt lgkmcnt(8)
    v_mfma_f32_16x16x32_bf16 v[56:59], v[200:203], v[36:39], v[56:59]
    v_cmp_gt_i32_e64 vcc, 0, v6
    v_cmp_gt_i32_e64 s[94:95], 1, v6
    s_nop 0
    v_cndmask_b32_e64 v240, v7, v8, vcc
    v_mfma_f32_16x16x32_bf16 v[60:63], v[204:207], v[36:39], v[60:63]
    v_cndmask_b32_e64 v241, v7, v8, s[94:95]
    v_cmp_gt_i32_e64 vcc, 2, v6
    v_cmp_gt_i32_e64 s[94:95], 3, v6
    s_waitcnt lgkmcnt(4)
    v_mfma_f32_16x16x32_bf16 v[56:59], v[152:155], v[40:43], v[56:59]
    v_cndmask_b32_e64 v242, v7, v8, vcc
    v_cndmask_b32_e64 v243, v7, v8, s[94:95]
    v_cmp_gt_i32_e64 vcc, 8, v6
    v_mfma_f32_16x16x32_bf16 v[60:63], v[156:159], v[40:43], v[60:63]
    v_cmp_gt_i32_e64 s[94:95], 9, v6
    v_cndmask_b32_e64 v244, v7, v8, vcc
    s_nop 0
    v_cndmask_b32_e64 v245, v7, v8, s[94:95]
    s_waitcnt lgkmcnt(0)
    v_mfma_f32_16x16x32_bf16 v[56:59], v[168:171], v[44:47], v[56:59]
    v_cmp_gt_i32_e64 vcc, 10, v6
    v_cmp_gt_i32_e64 s[94:95], 11, v6
    s_nop 0
    v_cndmask_b32_e64 v246, v7, v8, vcc
    v_mfma_f32_16x16x32_bf16 v[60:63], v[172:175], v[44:47], v[60:63]
    v_cndmask_b32_e64 v247, v7, v8, s[94:95]
    v_cmp_gt_i32_e64 vcc, 16, v6
    v_cmp_gt_i32_e64 s[94:95], 17, v6
    v_mfma_f32_16x16x32_bf16 v[48:51], v[176:179], v[32:35], v[48:51]
    v_cndmask_b32_e64 v248, v7, v8, vcc
    v_cndmask_b32_e64 v249, v7, v8, s[94:95]
    v_cmp_gt_i32_e64 vcc, 18, v6
    v_mfma_f32_16x16x32_bf16 v[52:55], v[180:183], v[32:35], v[52:55]
    v_cmp_gt_i32_e64 s[94:95], 19, v6
    v_cndmask_b32_e64 v250, v7, v8, vcc
    s_nop 0
    v_cndmask_b32_e64 v251, v7, v8, s[94:95]
    ds_write_b128 v11, v[56:59]
    ds_write_b128 v11, v[60:63] offset:1024
    v_add_u32 v5, 1, v5
    ds_write_b32 v208, v5
    v_mfma_f32_16x16x32_bf16 v[48:51], v[192:195], v[36:39], v[48:51]
    v_cmp_gt_i32_e64 vcc, 24, v6
    v_cmp_gt_i32_e64 s[94:95], 25, v6
    s_nop 0
    v_cndmask_b32_e64 v252, v7, v8, vcc
    v_mfma_f32_16x16x32_bf16 v[52:55], v[196:199], v[36:39], v[52:55]
    v_cndmask_b32_e64 v253, v7, v8, s[94:95]
    v_cmp_gt_i32_e64 vcc, 26, v6
    v_cmp_gt_i32_e64 s[94:95], 27, v6
    v_mfma_f32_16x16x32_bf16 v[48:51], v[144:147], v[40:43], v[48:51]
    v_cndmask_b32_e64 v254, v7, v8, vcc
    v_cndmask_b32_e64 v255, v7, v8, s[94:95]
    v_mfma_f32_16x16x32_bf16 v[52:55], v[148:151], v[40:43], v[52:55]
    v_mfma_f32_16x16x32_bf16 v[48:51], v[160:163], v[44:47], v[48:51]
    v_mfma_f32_16x16x32_bf16 v[52:55], v[164:167], v[44:47], v[52:55]
    ds_read_b32 v221, v209
    ds_read_b128 v[16:19], v10
    ds_read_b128 v[20:23], v10 offset:1024
    ds_read_b128 v[24:27], v229 offset:1024
    ds_read_b128 v[28:31], v229 offset:1088
    buffer_load_dwordx4 v[120:123], v1, s[8:11], s48 offen sc1
    buffer_load_dwordx4 v[124:127], v1, s[8:11], s49 offen sc1
    buffer_load_dwordx4 v[128:131], v1, s[8:11], s50 offen sc1
    buffer_load_dwordx4 v[132:135], v1, s[8:11], s51 offen sc1
    buffer_load_dwordx4 v[136:139], v1, s[8:11], s52 offen sc1
    v_mov_b64 v[64:65], 0
    v_mov_b64 v[66:67], 0
    v_mov_b64 v[68:69], 0
    v_mov_b64 v[70:71], 0
    v_mov_b64 v[72:73], 0
    v_mov_b64 v[74:75], 0
    v_mov_b64 v[76:77], 0
    v_mov_b64 v[78:79], 0
    s_waitcnt lgkmcnt(4)
pw_22:
    v_cmp_lt_u32 vcc, v221, v5
    s_nop 0
    s_and_b32 s30, vcc_lo, s75
    s_cbranch_scc1 pw_22f
pw_22o:
    s_waitcnt lgkmcnt(2)
    v_pk_add_f32 v[48:49], v[48:49], v[16:17]
    v_pk_add_f32 v[50:51], v[50:51], v[18:19]
    v_pk_add_f32 v[52:53], v[52:53], v[20:21]
    v_pk_add_f32 v[54:55], v[54:55], v[22:23]
    v_pk_mul_f32 v[48:49], v[48:49], v[214:215]
    v_pk_mul_f32 v[50:51], v[50:51], v[214:215]
    v_pk_mul_f32 v[52:53], v[52:53], v[214:215]
    v_pk_mul_f32 v[54:55], v[54:55], v[214:215]
    s_waitcnt lgkmcnt(0)
    v_pk_fma_f32 v[48:49], v[24:25], v[212:213], v[48:49]
    v_pk_fma_f32 v[50:51], v[26:27], v[212:213], v[50:51]
    v_pk_fma_f32 v[52:53], v[28:29], v[212:213], v[52:53]
    v_pk_fma_f32 v[54:55], v[30:31], v[212:213], v[54:55]
    v_cvt_pk_bf16_f32 v40, v48, v49
    v_cvt_pk_bf16_f32 v41, v50, v51
    v_cvt_pk_bf16_f32 v42, v52, v53
    v_cvt_pk_bf16_f32 v43, v54, v55
    ds_write_b128 v225, v[40:43]
    v_xor_b32 v7, 0x400, v231
    v_mov_b64 v[48:49], 0
    v_mov_b64 v[50:51], 0
    v_mov_b64 v[52:53], 0
    v_mov_b64 v[54:55], 0
    v_mov_b64 v[56:57], 0
    v_mov_b64 v[58:59], 0
    v_mov_b64 v[60:61], 0
    v_mov_b64 v[62:63], 0
    s_mov_b64 exec, s[44:45]
    buffer_load_dwordx4 v[80:83], v13, s[8:11], s48 offen offset:1024 sc1
    buffer_load_dwordx4 v[84:87], v13, s[8:11], s48 offen offset:1536 sc1
    s_mov_b64 exec, -1
    s_mov_b64 exec, s[44:45]
    buffer_load_dwordx4 v[88:91], v13, s[8:11], s49 offen offset:1024 sc1
    buffer_load_dwordx4 v[92:95], v13, s[8:11], s49 offen offset:1536 sc1
    s_mov_b64 exec, -1
    s_waitcnt lgkmcnt(0)
    s_barrier
    ds_read_b128 v[148:151], v231
    ds_read_b128 v[144:147], v7
    s_waitcnt vmcnt(4)
    v_max3_u32 v9, v120, v124, v128
    v_max3_u32 v9, v9, v132, v136
    v_cmp_eq_u32 vcc, -1, v9
    s_waitcnt lgkmcnt(0)
    s_cbranch_vccnz ab_fail1
ab_ok1:
    v_mfma_f32_32x32x16_bf16 v[16:31], v[120:123], v[148:151], v[240:255]
    s_nop 11
    v_exp_f32 v16, v16
    v_exp_f32 v17, v17
    s_mov_b64 exec, s[44:45]
    buffer_load_dwordx4 v[96:99], v13, s[8:11], s50 offen offset:1024 sc1
    buffer_load_dwordx4 v[100:103], v13, s[8:11], s50 offen offset:1536 sc1
    s_mov_b64 exec, -1
    v_exp_f32 v18, v18
    v_exp_f32 v19, v19
    v_exp_f32 v20, v20
    v_mfma_f32_32x32x16_bf16 v[32:47], v[124:127], v[144:147], v[240:255]
    v_exp_f32 v21, v21
    v_exp_f32 v22, v22
    v_exp_f32 v23, v23
    v_exp_f32 v24, v24
    v_exp_f32 v25, v25
    v_exp_f32 v26, v26
    v_exp_f32 v27, v27
    v_exp_f32 v28, v28
    v_exp_f32 v29, v29
    v_exp_f32 v30, v30
    v_exp_f32 v31, v31
    s_nop 0
    v_exp_f32 v32, v32
    v_exp_f32 v33, v33
    s_mov_b64 exec, s[44:45]
    buffer_load_dwordx4 v[104:107], v13, s[8:11], s51 offen offset:1024 sc1
    buffer_load_dwordx4 v[108:111], v13, s[8:11], s51 offen offset:1536 sc1
    s_mov_b64 exec, -1
    v_exp_f32 v34, v34
    v_exp_f32 v35, v35
    v_exp_f32 v36, v36
    v_mfma_f32_32x32x16_bf16 v[152:167], v[124:127], v[148:151], 0
    v_exp_f32 v37, v37
    v_exp_f32 v38, v38
    s_waitcnt vmcnt(6)
    v_max_u32 v9, v80, v84
    v_cmp_eq_u32 vcc, -1, v9
    v_exp_f32 v39, v39
    v_exp_f32 v40, v40
    v_exp_f32 v41, v41
    v_exp_f32 v42, v42
    s_cbranch_vccnz ab_fail2
ab_ok2:
    v_smfmac_f32_32x32x32_bf16 v[64:79], v[80:83], v[16:23], v12
    v_exp_f32 v43, v43
    v_exp_f32 v44, v44
    v_exp_f32 v45, v45
    v_exp_f32 v46, v46
    v_exp_f32 v47, v47
    v_exp_f32 v152, v152
    v_exp_f32 v153, v153
    v_smfmac_f32_32x32x32_bf16 v[64:79], v[84:87], v[24:31], v12
    s_mov_b64 exec, s[44:45]
    buffer_load_dwordx4 v[112:115], v13, s[8:11], s52 offen offset:1024 sc1
    buffer_load_dwordx4 v[116:119], v13, s[8:11], s52 offen offset:1536 sc1
    s_mov_b64 exec, -1
    v_exp_f32 v154, v154
    v_exp_f32 v155, v155
    v_exp_f32 v156, v156
    v_mfma_f32_32x32x16_bf16 v[16:31], v[128:131], v[144:147], 0
    v_exp_f32 v157, v157
    v_exp_f32 v158, v158
    s_waitcnt vmcnt(6)
    v_max_u32 v9, v88, v92
    v_cmp_eq_u32 vcc, -1, v9
    v_exp_f32 v159, v159
    v_exp_f32 v160, v160
    v_exp_f32 v161, v161
    v_exp_f32 v162, v162
    s_cbranch_vccnz ab_fail3
ab_ok3:
    v_smfmac_f32_32x32x32_bf16 v[48:63], v[88:91], v[32:39], v12
    v_exp_f32 v163, v163
    v_exp_f32 v164, v164
    v_exp_f32 v165, v165
    v_exp_f32 v166, v166
    v_exp_f32 v167, v167
    v_exp_f32 v16, v16
    v_exp_f32 v17, v17
    v_smfmac_f32_32x32x32_bf16 v[48:63], v[92:95], v[40:47], v12
    v_exp_f32 v18, v18
    v_exp_f32 v19, v19
    v_exp_f32 v20, v20
    v_mfma_f32_32x32x16_bf16 v[32:47], v[128:131], v[148:151], 0
    v_exp_f32 v21, v21
    v_exp_f32 v22, v22
    v_exp_f32 v23, v23
    v_exp_f32 v24, v24
    v_exp_f32 v25, v25
    v_exp_f32 v26, v26
    v_smfmac_f32_32x32x32_bf16 v[64:79], v[88:91], v[152:159], v12
    s_add_u32 m0, s41, 0x8000
    s_add_u32 s33, s39, 0x200000
    buffer_load_dwordx4 v1, s[8:11], s33 offen offset:0 lds
    buffer_load_dwordx4 v1, s[8:11], s33 offen offset:1024 lds
    buffer_load_dwordx4 v1, s[8:11], s33 offen offset:2048 lds
    buffer_load_dwordx4 v1, s[8:11], s33 offen offset:3072 lds
    v_exp_f32 v27, v27
    v_exp_f32 v28, v28
    v_exp_f32 v29, v29
    v_exp_f32 v30, v30
    v_exp_f32 v31, v31
    v_exp_f32 v32, v32
    v_exp_f32 v33, v33
    v_smfmac_f32_32x32x32_bf16 v[64:79], v[92:95], v[160:167], v12
    v_exp_f32 v34, v34
    v_exp_f32 v35, v35
    v_exp_f32 v36, v36
    v_mfma_f32_32x32x16_bf16 v[152:167], v[132:135], v[144:147], 0
    v_exp_f32 v37, v37
    v_exp_f32 v38, v38
    s_waitcnt vmcnt(8)
    v_max_u32 v9, v96, v100
    v_cmp_eq_u32 vcc, -1, v9
    v_exp_f32 v39, v39
    v_exp_f32 v40, v40
    v_exp_f32 v41, v41
    v_exp_f32 v42, v42
    s_cbranch_vccnz ab_fail4
ab_ok4:
    v_smfmac_f32_32x32x32_bf16 v[48:63], v[96:99], v[16:23], v12
    s_add_u32 m0, s41, 0x9000
    s_add_u32 s33, s39, 0x201000
    buffer_load_dwordx4 v1, s[8:11], s33 offen offset:0 lds
    buffer_load_dwordx4 v1, s[8:11], s33 offen offset:1024 lds
    buffer_load_dwordx4 v1, s[8:11], s33 offen offset:2048 lds
    buffer_load_dwordx4 v1, s[8:11], s33 offen offset:3072 lds
    v_exp_f32 v43, v43
    v_exp_f32 v44, v44
    v_exp_f32 v45, v45
    v_exp_f32 v46, v46
    v_exp_f32 v47, v47
    v_exp_f32 v152, v152
    v_exp_f32 v153, v153
    v_smfmac_f32_32x32x32_bf16 v[48:63], v[100:103], v[24:31], v12
    v_exp_f32 v154, v154
    v_exp_f32 v155, v155
    v_exp_f32 v156, v156
    v_mfma_f32_32x32x16_bf16 v[16:31], v[132:135], v[148:151], 0
    v_exp_f32 v157, v157
    v_exp_f32 v158, v158
    v_exp_f32 v159, v159
    v_exp_f32 v160, v160
    v_exp_f32 v161, v161
    v_exp_f32 v162, v162
    v_smfmac_f32_32x32x32_bf16 v[64:79], v[96:99], v[32:39], v12
    s_cmp_lg_u32 s25, 0
    s_cbranch_scc1 skq5
    s_add_u32 m0, s41, 0x0
    s_add_u32 s33, s39, 0x280000
    buffer_load_dwordx4 v1, s[8:11], s33 offen offset:0 lds
    buffer_load_dwordx4 v1, s[8:11], s33 offen offset:1024 lds
    buffer_load_dwordx4 v1, s[8:11], s33 offen offset:2048 lds
    buffer_load_dwordx4 v1, s[8:11], s33 offen offset:3072 lds
skq5:
    v_exp_f32 v163, v163
    v_exp_f32 v164, v164
    v_exp_f32 v165, v165
    v_exp_f32 v166, v166
    v_exp_f32 v167, v167
    v_exp_f32 v16, v16
    v_exp_f32 v17, v17
    v_smfmac_f32_32x32x32_bf16 v[64:79], v[100:103], v[40:47], v12
    v_exp_f32 v18, v18
    v_exp_f32 v19, v19
    v_exp_f32 v20, v20
    v_mfma_f32_32x32x16_bf16 v[32:47], v[136:139], v[144:147], 0
    v_exp_f32 v21, v21
    v_exp_f32 v22, v22
    s_waitcnt vmcnt(10)
    v_max_u32 v9, v104, v108
    v_cmp_eq_u32 vcc, -1, v9
    v_exp_f32 v23, v23
    v_exp_f32 v24, v24
    v_exp_f32 v25, v25
    v_exp_f32 v26, v26
    s_cbranch_vccnz ab_fail5
ab_ok5:
    v_smfmac_f32_32x32x32_bf16 v[48:63], v[104:107], v[152:159], v12
    s_cmp_lg_u32 s25, 0
    s_cbranch_scc1 skq6
    s_add_u32 m0, s41, 0x1000
    s_add_u32 s33, s39, 0x281000
    buffer_load_dwordx4 v1, s[8:11], s33 offen offset:0 lds
    buffer_load_dwordx4 v1, s[8:11], s33 offen offset:1024 lds
    buffer_load_dwordx4 v1, s[8:11], s33 offen offset:2048 lds
    buffer_load_dwordx4 v1, s[8:11], s33 offen offset:3072 lds
skq6:
    v_exp_f32 v27, v27
    v_exp_f32 v28, v28
    v_exp_f32 v29, v29
    v_exp_f32 v30, v30
    v_exp_f32 v31, v31
    v_exp_f32 v32, v32
    v_exp_f32 v33, v33
    v_smfmac_f32_32x32x32_bf16 v[48:63], v[108:111], v[160:167], v12
    v_exp_f32 v34, v34
    v_exp_f32 v35, v35
    v_exp_f32 v36, v36
    v_mfma_f32_32x32x16_bf16 v[152:167], v[136:139], v[148:151], 0
    v_exp_f32 v37, v37
    v_exp_f32 v38, v38
    v_exp_f32 v39, v39
    v_exp_f32 v40, v40
    v_exp_f32 v41, v41
    v_exp_f32 v42, v42
    v_smfmac_f32_32x32x32_bf16 v[64:79], v[104:107], v[16:23], v12
    v_lshrrev_b32 v6, 2, v1
    v_sub_u32 v6, v6, v1
    v_add_u32 v7, v10, v6
    v_add_u32 v8, v11, v6
    v_exp_f32 v43, v43
    v_exp_f32 v44, v44
    v_exp_f32 v45, v45
    v_exp_f32 v46, v46
    v_exp_f32 v47, v47
    v_exp_f32 v152, v152
    v_exp_f32 v153, v153
    v_smfmac_f32_32x32x32_bf16 v[64:79], v[108:111], v[24:31], v12
    v_exp_f32 v154, v154
    v_exp_f32 v155, v155
    v_exp_f32 v156, v156
    v_exp_f32 v157, v157
    v_exp_f32 v158, v158
    s_waitcnt vmcnt(8)
    v_max_u32 v9, v112, v116
    v_cmp_eq_u32 vcc, -1, v9
    v_exp_f32 v159, v159
    v_exp_f32 v160, v160
    v_exp_f32 v161, v161
    v_exp_f32 v162, v162
    s_cbranch_vccnz ab_fail6
ab_ok6:
    v_smfmac_f32_32x32x32_bf16 v[48:63], v[112:115], v[32:39], v12
    v_exp_f32 v163, v163
    v_exp_f32 v164, v164
    v_exp_f32 v165, v165
    v_exp_f32 v166, v166
    v_exp_f32 v167, v167
    v_smfmac_f32_32x32x32_bf16 v[48:63], v[116:119], v[40:47], v12
    v_smfmac_f32_32x32x32_bf16 v[64:79], v[112:115], v[152:159], v12
    v_smfmac_f32_32x32x32_bf16 v[64:79], v[116:119], v[160:167], v12
    s_nop 9
    ds_write_b128 v10, v[48:51]
    ds_write_b128 v10, v[52:55] offset:1024
    ds_write_b32 v7, v56 offset:2048
    v_add_u32 v5, 1, v5
    ds_write_b32 v208, v5
    ds_read_b32 v221, v209
    ds_read_b32 v56, v8 offset:2048
    ds_read_b128 v[48:51], v11
    ds_read_b128 v[52:55], v11 offset:1024
    s_waitcnt lgkmcnt(3)
pw_23:
    v_cmp_lt_u32 vcc, v221, v5
    s_nop 0
    s_and_b32 s30, vcc_lo, s75
    s_cbranch_scc1 pw_23f
pw_23o:
    s_waitcnt lgkmcnt(2)
    v_add_f32 v72, v72, v56
    v_rcp_f32 v6, v72
    v_subrev_u32 v9, 0x1f800000, v72
    v_cmp_le_u32 vcc, 0x40000000, v9
    s_waitcnt lgkmcnt(0)
    v_pk_add_f32 v[64:65], v[64:65], v[48:49]
    v_pk_add_f32 v[66:67], v[66:67], v[50:51]
    v_pk_add_f32 v[68:69], v[68:69], v[52:53]
    v_pk_add_f32 v[70:71], v[70:71], v[54:55]
    s_cbranch_vccnz ab_fb
ab_norm:
    s_add_u32 s26, s36, 0x20000
    v_mov_b32 v7, v6
    v_pk_mul_f32 v[64:65], v[64:65], v[6:7]
    v_pk_mul_f32 v[66:67], v[66:67], v[6:7]
    v_pk_mul_f32 v[68:69], v[68:69], v[6:7]
    v_pk_mul_f32 v[70:71], v[70:71], v[6:7]
    v_cvt_pk_bf16_f32 v216, v64, v65
    v_cvt_pk_bf16_f32 v217, v66, v67
    v_cvt_pk_bf16_f32 v218, v68, v69
    v_cvt_pk_bf16_f32 v219, v70, v71
    s_cmp_lg_u32 s43, 0
    s_cbranch_scc0 ps_24
    buffer_store_dwordx4 v[216:219], v14, s[8:11], s26 offen
ps_25:
    s_waitcnt vmcnt(1)
    s_barrier
    s_add_u32 s96, s34, 0x20000
    s_add_u32 s97, s96, 0x1000
    buffer_load_dwordx4 v[16:19], v1, s[8:11], s96 offen offset:0 sc1
    buffer_load_dwordx4 v[20:23], v1, s[8:11], s96 offen offset:1024 sc1
    buffer_load_dwordx4 v[24:27], v1, s[8:11], s96 offen offset:2048 sc1
    buffer_load_dwordx4 v[28:31], v1, s[8:11], s96 offen offset:3072 sc1
    buffer_load_dwordx4 v[32:35], v1, s[8:11], s97 offen offset:0 sc1
    buffer_load_dwordx4 v[36:39], v1, s[8:11], s97 offen offset:1024 sc1
    buffer_load_dwordx4 v[40:43], v1, s[8:11], s97 offen offset:2048 sc1
    buffer_load_dwordx4 v[44:47], v1, s[8:11], s97 offen offset:3072 sc1
    ds_read_b128 v[168:171], v211 offset:34816
    ds_read_b128 v[172:175], v211 offset:35840
    ds_read_b128 v[160:163], v211 offset:32768
    ds_read_b128 v[164:167], v211 offset:33792
    ds_read_b128 v[184:187], v211 offset:38912
    ds_read_b128 v[188:191], v211 offset:39936
    ds_read_b128 v[176:179], v211 offset:36864
    ds_read_b128 v[180:183], v211 offset:37888
    ds_read_b128 v[200:203], v211 offset:43008
    ds_read_b128 v[204:207], v211 offset:44032
    ds_read_b128 v[192:195], v211 offset:40960
    ds_read_b128 v[196:199], v211 offset:41984
    ds_read_b128 v[152:155], v211 offset:47104
    ds_read_b128 v[156:159], v211 offset:48128
    ds_read_b128 v[144:147], v211 offset:45056
    ds_read_b128 v[148:151], v211 offset:46080
    ds_read_b128 v[84:87], v211 offset:51200
    ds_read_b128 v[116:119], v211 offset:52224
    ds_read_b128 v[112:115], v211 offset:49152
    ds_read_b128 v[80:83], v211 offset:50176
    ds_read_b128 v[120:123], v211 offset:55296
    ds_read_b128 v[96:99], v211 offset:56320
    ds_read_b128 v[88:91], v211 offset:53248
    ds_read_b128 v[92:95], v211 offset:54272
    ds_read_b128 v[104:107], v211 offset:59392
    ds_read_b128 v[108:111], v211 offset:60416
    ds_read_b128 v[100:103], v211 offset:57344
    ds_read_b128 v[124:127], v211 offset:58368
    ds_read_b128 v[136:139], v211 offset:63488
    ds_read_b128 v[140:143], v211 offset:64512
    ds_read_b128 v[128:131], v211 offset:61440
    ds_read_b128 v[132:135], v211 offset:62464
    v_lshlrev_b32 v48, 16, v236
    v_and_b32 v49, 0xffff0000, v236
    v_lshlrev_b32 v50, 16, v237
    v_and_b32 v51, 0xffff0000, v237
    v_lshlrev_b32 v52, 16, v238
    v_and_b32 v53, 0xffff0000, v238
    v_lshlrev_b32 v54, 16, v239
    v_and_b32 v55, 0xffff0000, v239
    s_waitcnt vmcnt(7)
    v_cmp_eq_u32_e64 s[94:95], -1, v19
    s_nop 0
    s_cmp_lg_u64 s[94:95], 0
    s_cbranch_scc1 pb_f0
pb_o0:
    s_waitcnt lgkmcnt(14)
    v_mfma_f32_16x16x32_bf16 v[56:59], v[168:171], v[16:19], 0
    v_mfma_f32_16x16x32_bf16 v[60:63], v[172:175], v[16:19], 0
    s_waitcnt vmcnt(6)
    v_cmp_eq_u32_e64 s[94:95], -1, v23
    v_mfma_f32_16x16x32_bf16 v[48:51], v[160:163], v[16:19], v[48:51]
    v_mfma_f32_16x16x32_bf16 v[52:55], v[164:167], v[16:19], v[52:55]
    s_cmp_lg_u64 s[94:95], 0
    s_cbranch_scc1 pb_f1
pb_o1:
    v_mfma_f32_16x16x32_bf16 v[56:59], v[184:187], v[20:23], v[56:59]
    ds_read_b128 v[168:171], v211 offset:2048
    ds_read_b128 v[172:175], v211 offset:3072
    v_mfma_f32_16x16x32_bf16 v[60:63], v[188:191], v[20:23], v[60:63]
    ds_read_b128 v[160:163], v211 offset:0
    ds_read_b128 v[164:167], v211 offset:1024
    s_waitcnt vmcnt(5)
    v_cmp_eq_u32_e64 s[94:95], -1, v27
    v_mfma_f32_16x16x32_bf16 v[48:51], v[176:179], v[20:23], v[48:51]
    v_mfma_f32_16x16x32_bf16 v[52:55], v[180:183], v[20:23], v[52:55]
    s_cmp_lg_u64 s[94:95], 0
    s_cbranch_scc1 pb_f2
pb_o2:
    v_mfma_f32_16x16x32_bf16 v[56:59], v[200:203], v[24:27], v[56:59]
    v_mfma_f32_16x16x32_bf16 v[60:63], v[204:207], v[24:27], v[60:63]
    s_waitcnt vmcnt(4)
    v_cmp_eq_u32_e64 s[94:95], -1, v31
    v_mfma_f32_16x16x32_bf16 v[48:51], v[192:195], v[24:27], v[48:51]
    v_mfma_f32_16x16x32_bf16 v[52:55], v[196:199], v[24:27], v[52:55]
    s_cmp_lg_u64 s[94:95], 0
    s_cbranch_scc1 pb_f3
pb_o3:
    v_mfma_f32_16x16x32_bf16 v[56:59], v[152:155], v[28:31], v[56:59]
    v_mfma_f32_16x16x32_bf16 v[60:63], v[156:159], v[28:31], v[60:63]
    s_waitcnt vmcnt(3)
    v_cmp_eq_u32_e64 s[94:95], -1, v35
    v_mfma_f32_16x16x32_bf16 v[48:51], v[144:147], v[28:31], v[48:51]
    v_mfma_f32_16x16x32_bf16 v[52:55], v[148:151], v[28:31], v[52:55]
    s_cmp_lg_u64 s[94:95], 0
    s_cbranch_scc1 pb_f4
pb_o4:
    s_waitcnt lgkmcnt(14)
    v_mfma_f32_16x16x32_bf16 v[56:59], v[84:87], v[32:35], v[56:59]
    ds_read_b128 v[152:155], v211 offset:6144
    ds_read_b128 v[156:159], v211 offset:7168
    v_mfma_f32_16x16x32_bf16 v[60:63], v[116:119], v[32:35], v[60:63]
    ds_read_b128 v[144:147], v211 offset:4096
    ds_read_b128 v[148:151], v211 offset:5120
    s_waitcnt vmcnt(2)
    v_cmp_eq_u32_e64 s[94:95], -1, v39
    v_mfma_f32_16x16x32_bf16 v[48:51], v[112:115], v[32:35], v[48:51]
    v_mfma_f32_16x16x32_bf16 v[52:55], v[80:83], v[32:35], v[52:55]
    s_cmp_lg_u64 s[94:95], 0
    s_cbranch_scc1 pb_f5
pb_o5:
    s_waitcnt lgkmcnt(14)
    s_waitcnt vmcnt(1)
    v_cmp_eq_u32_e64 s[94:95], -1, v43
    v_mfma_f32_16x16x32_bf16 v[56:59], v[120:123], v[36:39], v[56:59]
    ds_read_b128 v[84:87], v211 offset:10240
    ds_read_b128 v[116:119], v211 offset:11264
    v_mfma_f32_16x16x32_bf16 v[60:63], v[96:99], v[36:39], v[60:63]
    ds_read_b128 v[112:115], v211 offset:8192
    ds_read_b128 v[80:83], v211 offset:9216
    s_cmp_lg_u64 s[94:95], 0
    s_cbranch_scc1 pb_f6
pb_o6:
    s_waitcnt lgkmcnt(14)
    s_waitcnt vmcnt(0)
    v_cmp_eq_u32_e64 s[94:95], -1, v47
    v_mfma_f32_16x16x32_bf16 v[56:59], v[104:107], v[40:43], v[56:59]
    v_mfma_f32_16x16x32_bf16 v[60:63], v[108:111], v[40:43], v[60:63]
    s_cmp_lg_u64 s[94:95], 0
    s_cbranch_scc1 pb_f7
pb_o7:
    s_waitcnt lgkmcnt(12)
    v_mfma_f32_16x16x32_bf16 v[56:59], v[136:139], v[44:47], v[56:59]
    v_mfma_f32_16x16x32_bf16 v[60:63], v[140:143], v[44:47], v[60:63]
    v_mfma_f32_16x16x32_bf16 v[48:51], v[88:91], v[36:39], v[48:51]
    v_mfma_f32_16x16x32_bf16 v[52:55], v[92:95], v[36:39], v[52:55]
    v_mfma_f32_16x16x32_bf16 v[48:51], v[100:103], v[40:43], v[48:51]
    s_nop 3
    ds_write_b128 v11, v[56:59]
    ds_write_b128 v11, v[60:63] offset:1024
    v_add_u32 v5, 1, v5
    ds_write_b32 v208, v5
    v_mfma_f32_16x16x32_bf16 v[52:55], v[124:127], v[40:43], v[52:55]
    v_mfma_f32_16x16x32_bf16 v[48:51], v[128:131], v[44:47], v[48:51]
    v_mfma_f32_16x16x32_bf16 v[52:55], v[132:135], v[44:47], v[52:55]
    ds_read_b32 v221, v209
    ds_read_b128 v[64:67], v10
    ds_read_b128 v[68:71], v10 offset:1024
    ds_read_b128 v[120:123], v211 offset:14336
    ds_read_b128 v[96:99], v211 offset:15360
    ds_read_b128 v[88:91], v211 offset:12288
    ds_read_b128 v[92:95], v211 offset:13312
    ds_read_b128 v[104:107], v211 offset:18432
    ds_read_b128 v[108:111], v211 offset:19456
    ds_read_b128 v[100:103], v211 offset:16384
    ds_read_b128 v[124:127], v211 offset:17408
    ds_read_b128 v[136:139], v211 offset:22528
    ds_read_b128 v[140:143], v211 offset:23552
    ds_read_b128 v[128:131], v211 offset:20480
    ds_read_b128 v[132:135], v211 offset:21504
    s_waitcnt lgkmcnt(14)
pw_26:
    v_cmp_lt_u32 vcc, v221, v5
    s_nop 0
    s_and_b32 s30, vcc_lo, s75
    s_cbranch_scc1 pw_26f
pw_26o:
    s_waitcnt lgkmcnt(12)
    v_pk_add_f32 v[48:49], v[48:49], v[64:65]
    v_pk_add_f32 v[50:51], v[50:51], v[66:67]
    v_pk_add_f32 v[52:53], v[52:53], v[68:69]
    v_pk_add_f32 v[54:55], v[54:55], v[70:71]
    v_cvt_pk_bf16_f32 v236, v48, v49
    v_cvt_pk_bf16_f32 v237, v50, v51
    v_cvt_pk_bf16_f32 v238, v52, v53
    v_cvt_pk_bf16_f32 v239, v54, v55
    s_cmp_lg_u32 s25, 0
    s_cbranch_scc1 final
    s_add_u32 s26, s35, 0x30000
    s_cmp_lg_u32 s43, 0
    s_cbranch_scc0 ps_27
    buffer_store_dwordx4 v[236:239], v1, s[8:11], s26 offen
ps_28:
    s_cmp_eq_u32 s54, 0
    s_cbranch_scc1 noreload
    s_add_u32 s28, s78, 0x1000
    buffer_load_dwordx4 v[176:179], v1, s[8:11], s78 offen offset:0
    buffer_load_dwordx4 v[180:183], v1, s[8:11], s78 offen offset:1024
    buffer_load_dwordx4 v[184:187], v1, s[8:11], s78 offen offset:2048
    buffer_load_dwordx4 v[188:191], v1, s[8:11], s78 offen offset:3072
    buffer_load_dwordx4 v[192:195], v1, s[8:11], s28 offen offset:0
    buffer_load_dwordx4 v[196:199], v1, s[8:11], s28 offen offset:1024
    buffer_load_dwordx4 v[200:203], v1, s[8:11], s28 offen offset:2048
    buffer_load_dwordx4 v[204:207], v1, s[8:11], s28 offen offset:3072
noreload:
    s_mov_b32 s25, 1
    s_add_u32 s38, s38, 0x20000
    s_add_u32 s40, s40, 0x400
    s_branch loop_top
final:
    buffer_store_dwordx4 v[236:239], v220, s[16:19], s42 offen
    s_endpgm
act_repoll:
    s_waitcnt vmcnt(0)
    s_mov_b32 s29, 0
    v_cmp_eq_u32 vcc, -1, v19
    s_nop 0
    s_cbranch_vccz act_repoll_s0
    buffer_load_dwordx4 v[16:19], v1, s[8:11], s96 offen offset:0 sc1
    s_mov_b32 s29, 1
act_repoll_s0:
    v_cmp_eq_u32 vcc, -1, v23
    s_nop 0
    s_cbranch_vccz act_repoll_s1
    buffer_load_dwordx4 v[20:23], v1, s[8:11], s96 offen offset:1024 sc1
    s_mov_b32 s29, 1
act_repoll_s1:
    v_cmp_eq_u32 vcc, -1, v27
    s_nop 0
    s_cbranch_vccz act_repoll_s2
    buffer_load_dwordx4 v[24:27], v1, s[8:11], s96 offen offset:2048 sc1
    s_mov_b32 s29, 1
act_repoll_s2:
    v_cmp_eq_u32 vcc, -1, v31
    s_nop 0
    s_cbranch_vccz act_repoll_s3
    buffer_load_dwordx4 v[28:31], v1, s[8:11], s96 offen offset:3072 sc1
    s_mov_b32 s29, 1
act_repoll_s3:
    v_cmp_eq_u32 vcc, -1, v35
    s_nop 0
    s_cbranch_vccz act_repoll_s4
    buffer_load_dwordx4 v[32:35], v1, s[8:11], s97 offen offset:0 sc1
    s_mov_b32 s29, 1
act_repoll_s4:
    v_cmp_eq_u32 vcc, -1, v39
    s_nop 0
    s_cbranch_vccz act_repoll_s5
    buffer_load_dwordx4 v[36:39], v1, s[8:11], s97 offen offset:1024 sc1
    s_mov_b32 s29, 1
act_repoll_s5:
    v_cmp_eq_u32 vcc, -1, v43
    s_nop 0
    s_cbranch_vccz act_repoll_s6
    buffer_load_dwordx4 v[40:43], v1, s[8:11], s97 offen offset:2048 sc1
    s_mov_b32 s29, 1
act_repoll_s6:
    v_cmp_eq_u32 vcc, -1, v47
    s_nop 0
    s_cbranch_vccz act_repoll_s7
    buffer_load_dwordx4 v[44:47], v1, s[8:11], s97 offen offset:3072 sc1
    s_mov_b32 s29, 1
act_repoll_s7:
    s_cmp_eq_u32 s29, 0
    s_cbranch_scc1 act_repoll_r
    s_cmp_lg_u32 s46, 0
    s_cbranch_scc1 act_repoll_g
    s_add_u32 s47, s47, 1
    s_cmp_ge_u32 s47, 0xf4240
    s_cselect_b32 s46, 1, 0
    s_branch act_repoll
act_repoll_g:
    s_waitcnt vmcnt(0)
act_repoll_r:
    s_setpc_b64 s[98:99]
b_repoll:
    s_waitcnt vmcnt(0)
    s_mov_b32 s29, 0
    v_max3_u32 v9, v120, v80, v84
    v_cmp_eq_u32 vcc, -1, v9
    s_nop 0
    s_cbranch_vccz b_repoll_s0
    buffer_load_dwordx4 v[120:123], v1, s[8:11], s48 offen sc1
    s_mov_b64 exec, s[44:45]
    buffer_load_dwordx4 v[80:83], v13, s[8:11], s48 offen offset:1024 sc1
    buffer_load_dwordx4 v[84:87], v13, s[8:11], s48 offen offset:1536 sc1
    s_mov_b64 exec, -1
    s_mov_b32 s29, 1
b_repoll_s0:
    v_max3_u32 v9, v124, v88, v92
    v_cmp_eq_u32 vcc, -1, v9
    s_nop 0
    s_cbranch_vccz b_repoll_s1
    buffer_load_dwordx4 v[124:127], v1, s[8:11], s49 offen sc1
    s_mov_b64 exec, s[44:45]
    buffer_load_dwordx4 v[88:91], v13, s[8:11], s49 offen offset:1024 sc1
    buffer_load_dwordx4 v[92:95], v13, s[8:11], s49 offen offset:1536 sc1
    s_mov_b64 exec, -1
    s_mov_b32 s29, 1
b_repoll_s1:
    v_max3_u32 v9, v128, v96, v100
    v_cmp_eq_u32 vcc, -1, v9
    s_nop 0
    s_cbranch_vccz b_repoll_s2
    buffer_load_dwordx4 v[128:131], v1, s[8:11], s50 offen sc1
    s_mov_b64 exec, s[44:45]
    buffer_load_dwordx4 v[96:99], v13, s[8:11], s50 offen offset:1024 sc1
    buffer_load_dwordx4 v[100:103], v13, s[8:11], s50 offen offset:1536 sc1
    s_mov_b64 exec, -1
    s_mov_b32 s29, 1
b_repoll_s2:
    v_max3_u32 v9, v132, v104, v108
    v_cmp_eq_u32 vcc, -1, v9
    s_nop 0
    s_cbranch_vccz b_repoll_s3
    buffer_load_dwordx4 v[132:135], v1, s[8:11], s51 offen sc1
    s_mov_b64 exec, s[44:45]
    buffer_load_dwordx4 v[104:107], v13, s[8:11], s51 offen offset:1024 sc1
    buffer_load_dwordx4 v[108:111], v13, s[8:11], s51 offen offset:1536 sc1
    s_mov_b64 exec, -1
    s_mov_b32 s29, 1
b_repoll_s3:
    v_max3_u32 v9, v136, v112, v116
    v_cmp_eq_u32 vcc, -1, v9
    s_nop 0
    s_cbranch_vccz b_repoll_s4
    buffer_load_dwordx4 v[136:139], v1, s[8:11], s52 offen sc1
    s_mov_b64 exec, s[44:45]
    buffer_load_dwordx4 v[112:115], v13, s[8:11], s52 offen offset:1024 sc1
    buffer_load_dwordx4 v[116:119], v13, s[8:11], s52 offen offset:1536 sc1
    s_mov_b64 exec, -1
    s_mov_b32 s29, 1
b_repoll_s4:
    s_cmp_eq_u32 s29, 0
    s_cbranch_scc1 b_repoll_r
    s_cmp_lg_u32 s46, 0
    s_cbranch_scc1 b_repoll_g
    s_add_u32 s47, s47, 1
    s_cmp_ge_u32 s47, 0xf4240
    s_cselect_b32 s46, 1, 0
    s_branch b_repoll
b_repoll_g:
    s_waitcnt vmcnt(0)
b_repoll_r:
    s_setpc_b64 s[98:99]
qa0_f0:
    s_cmp_eq_u32 s25, 0
    s_cbranch_scc1 qa0_o0
    s_call_b64 s[98:99], act_repoll
    s_branch qa0_o0
qa0_f1:
    s_cmp_eq_u32 s25, 0
    s_cbranch_scc1 qa0_o1
    s_call_b64 s[98:99], act_repoll
    s_branch qa0_o1
lr01t:
    ds_read_b64_tr_b16 v[168:169], v214 offset:24960
    ds_read_b64_tr_b16 v[170:171], v214 offset:25472
    ds_read_b64_tr_b16 v[172:173], v215 offset:24960
    ds_read_b64_tr_b16 v[174:175], v215 offset:25472
    ds_read_b64_tr_b16 v[160:161], v212 offset:24960
    ds_read_b64_tr_b16 v[162:163], v212 offset:25472
    ds_read_b64_tr_b16 v[164:165], v213 offset:24960
    ds_read_b64_tr_b16 v[166:167], v213 offset:25472
    s_branch lr01o
qa0_f2:
    s_cmp_eq_u32 s25, 0
    s_cbranch_scc1 qa0_o2
    s_call_b64 s[98:99], act_repoll
    s_branch qa0_o2
lr02t:
    ds_read_b64_tr_b16 v[152:153], v214 offset:29120
    ds_read_b64_tr_b16 v[154:155], v214 offset:29632
    ds_read_b64_tr_b16 v[156:157], v215 offset:29120
    ds_read_b64_tr_b16 v[158:159], v215 offset:29632
    ds_read_b64_tr_b16 v[144:145], v212 offset:29120
    ds_read_b64_tr_b16 v[146:147], v212 offset:29632
    ds_read_b64_tr_b16 v[148:149], v213 offset:29120
    ds_read_b64_tr_b16 v[150:151], v213 offset:29632
    s_branch lr02o
qa0_f3:
    s_cmp_eq_u32 s25, 0
    s_cbranch_scc1 qa0_o3
    s_call_b64 s[98:99], act_repoll
    s_branch qa0_o3
qa0_f4:
    s_cmp_eq_u32 s25, 0
    s_cbranch_scc1 qa0_o4
    s_call_b64 s[98:99], act_repoll
    s_branch qa0_o4
qa0_f5:
    s_cmp_eq_u32 s25, 0
    s_cbranch_scc1 qa0_o5
    s_call_b64 s[98:99], act_repoll
    s_branch qa0_o5
qa0_f6:
    s_cmp_eq_u32 s25, 0
    s_cbranch_scc1 qa0_o6
    s_call_b64 s[98:99], act_repoll
    s_branch qa0_o6
qa0_f7:
    s_cmp_eq_u32 s25, 0
    s_cbranch_scc1 qa0_o7
    s_call_b64 s[98:99], act_repoll
    s_branch qa0_o7
qa1_f0:
    s_cmp_eq_u32 s25, 0
    s_cbranch_scc1 qa1_o0
    s_call_b64 s[98:99], act_repoll
    s_branch qa1_o0
qa1_f1:
    s_cmp_eq_u32 s25, 0
    s_cbranch_scc1 qa1_o1
    s_call_b64 s[98:99], act_repoll
    s_branch qa1_o1
lr11t:
    ds_read_b64_tr_b16 v[168:169], v214 offset:24960
    ds_read_b64_tr_b16 v[170:171], v214 offset:25472
    ds_read_b64_tr_b16 v[172:173], v215 offset:24960
    ds_read_b64_tr_b16 v[174:175], v215 offset:25472
    ds_read_b64_tr_b16 v[160:161], v212 offset:24960
    ds_read_b64_tr_b16 v[162:163], v212 offset:25472
    ds_read_b64_tr_b16 v[164:165], v213 offset:24960
    ds_read_b64_tr_b16 v[166:167], v213 offset:25472
    s_branch lr11o
qa1_f2:
    s_cmp_eq_u32 s25, 0
    s_cbranch_scc1 qa1_o2
    s_call_b64 s[98:99], act_repoll
    s_branch qa1_o2
lr12t:
    ds_read_b64_tr_b16 v[152:153], v214 offset:29120
    ds_read_b64_tr_b16 v[154:155], v214 offset:29632
    ds_read_b64_tr_b16 v[156:157], v215 offset:29120
    ds_read_b64_tr_b16 v[158:159], v215 offset:29632
    ds_read_b64_tr_b16 v[144:145], v212 offset:29120
    ds_read_b64_tr_b16 v[146:147], v212 offset:29632
    ds_read_b64_tr_b16 v[148:149], v213 offset:29120
    ds_read_b64_tr_b16 v[150:151], v213 offset:29632
    s_branch lr12o
qa1_f3:
    s_cmp_eq_u32 s25, 0
    s_cbranch_scc1 qa1_o3
    s_call_b64 s[98:99], act_repoll
    s_branch qa1_o3
qa1_f4:
    s_cmp_eq_u32 s25, 0
    s_cbranch_scc1 qa1_o4
    s_call_b64 s[98:99], act_repoll
    s_branch qa1_o4
qa1_f5:
    s_cmp_eq_u32 s25, 0
    s_cbranch_scc1 qa1_o5
    s_call_b64 s[98:99], act_repoll
    s_branch qa1_o5
qa1_f6:
    s_cmp_eq_u32 s25, 0
    s_cbranch_scc1 qa1_o6
    s_call_b64 s[98:99], act_repoll
    s_branch qa1_o6
qa1_f7:
    s_cmp_eq_u32 s25, 0
    s_cbranch_scc1 qa1_o7
    s_call_b64 s[98:99], act_repoll
    s_branch qa1_o7
pw_1f:
    s_cmp_lg_u32 s46, 0
    s_cbranch_scc1 pw_1o
    s_add_u32 s47, s47, 1
    s_cmp_ge_u32 s47, 0xf4240
    s_cselect_b32 s46, 1, 0
    ds_read_b32 v221, v209
    ds_read_b128 v[176:179], v8
    ds_read_b128 v[180:183], v8 offset:1024
    ds_read_b128 v[184:187], v227
    s_waitcnt lgkmcnt(0)
    s_branch pw_1
qa2_f0:
    s_cmp_eq_u32 s25, 0
    s_cbranch_scc1 qa2_o0
    s_call_b64 s[98:99], act_repoll
    s_branch qa2_o0
qa2_f1:
    s_cmp_eq_u32 s25, 0
    s_cbranch_scc1 qa2_o1
    s_call_b64 s[98:99], act_repoll
    s_branch qa2_o1
lr21t:
    ds_read_b64_tr_b16 v[168:169], v214 offset:24960
    ds_read_b64_tr_b16 v[170:171], v214 offset:25472
    ds_read_b64_tr_b16 v[172:173], v215 offset:24960
    ds_read_b64_tr_b16 v[174:175], v215 offset:25472
    ds_read_b64_tr_b16 v[160:161], v212 offset:24960
    ds_read_b64_tr_b16 v[162:163], v212 offset:25472
    ds_read_b64_tr_b16 v[164:165], v213 offset:24960
    ds_read_b64_tr_b16 v[166:167], v213 offset:25472
    s_branch lr21o
qa2_f2:
    s_cmp_eq_u32 s25, 0
    s_cbranch_scc1 qa2_o2
    s_call_b64 s[98:99], act_repoll
    s_branch qa2_o2
lr22t:
    ds_read_b64_tr_b16 v[152:153], v214 offset:29120
    ds_read_b64_tr_b16 v[154:155], v214 offset:29632
    ds_read_b64_tr_b16 v[156:157], v215 offset:29120
    ds_read_b64_tr_b16 v[158:159], v215 offset:29632
    ds_read_b64_tr_b16 v[144:145], v212 offset:29120
    ds_read_b64_tr_b16 v[146:147], v212 offset:29632
    ds_read_b64_tr_b16 v[148:149], v213 offset:29120
    ds_read_b64_tr_b16 v[150:151], v213 offset:29632
    s_branch lr22o
qa2_f3:
    s_cmp_eq_u32 s25, 0
    s_cbranch_scc1 qa2_o3
    s_call_b64 s[98:99], act_repoll
    s_branch qa2_o3
qa2_f4:
    s_cmp_eq_u32 s25, 0
    s_cbranch_scc1 qa2_o4
    s_call_b64 s[98:99], act_repoll
    s_branch qa2_o4
qa2_f5:
    s_cmp_eq_u32 s25, 0
    s_cbranch_scc1 qa2_o5
    s_call_b64 s[98:99], act_repoll
    s_branch qa2_o5
qa2_f6:
    s_cmp_eq_u32 s25, 0
    s_cbranch_scc1 qa2_o6
    s_call_b64 s[98:99], act_repoll
    s_branch qa2_o6
qa2_f7:
    s_cmp_eq_u32 s25, 0
    s_cbranch_scc1 qa2_o7
    s_call_b64 s[98:99], act_repoll
    s_branch qa2_o7
pw_2f:
    s_cmp_lg_u32 s46, 0
    s_cbranch_scc1 pw_2o
    s_add_u32 s47, s47, 1
    s_cmp_ge_u32 s47, 0xf4240
    s_cselect_b32 s46, 1, 0
    ds_read_b32 v221, v209
    ds_read_b128 v[176:179], v8
    ds_read_b128 v[180:183], v8 offset:1024
    ds_read_b128 v[184:187], v228 offset:0
    ds_read_b128 v[188:191], v228 offset:16
    ds_read_b128 v[192:195], v228 offset:32
    ds_read_b128 v[196:199], v228 offset:48
    s_waitcnt lgkmcnt(0)
    s_branch pw_2
pw_3f:
    s_cmp_lg_u32 s46, 0
    s_cbranch_scc1 pw_3o
    s_add_u32 s47, s47, 1
    s_cmp_ge_u32 s47, 0xf4240
    s_cselect_b32 s46, 1, 0
    ds_read_b32 v221, v209
    ds_read_b128 v[16:19], v227
    ds_read_b128 v[20:23], v11
    ds_read_b128 v[24:27], v11 offset:1024
    ds_read_b128 v[176:179], v229 offset:1536
    ds_read_b128 v[180:183], v229 offset:1600
    ds_read_b128 v[184:187], v229 offset:1792
    ds_read_b128 v[188:191], v229 offset:1856
    s_waitcnt lgkmcnt(0)
    s_branch pw_3
pw_4f:
    s_cmp_lg_u32 s46, 0
    s_cbranch_scc1 pw_4o
    s_add_u32 s47, s47, 1
    s_cmp_ge_u32 s47, 0xf4240
    s_cselect_b32 s46, 1, 0
    ds_read_b32 v221, v209
    ds_read_b128 v[16:19], v227
    ds_read_b128 v[20:23], v11
    ds_read_b128 v[24:27], v11 offset:1024
    ds_read_b128 v[176:179], v229 offset:1536
    ds_read_b128 v[180:183], v229 offset:1600
    ds_read_b128 v[184:187], v229 offset:1792
    ds_read_b128 v[188:191], v229 offset:1856
    s_waitcnt lgkmcnt(0)
    s_branch pw_4
aa_fail0:
    s_cmp_lg_u32 s46, 0
    s_cbranch_scc1 aa_ok0
    s_add_u32 s47, s47, 1
    s_cmp_ge_u32 s47, 0xf4240
    s_cselect_b32 s46, 1, 0
    s_sleep 1
    s_add_u32 s26, s57, 0x0
    s_and_b32 s26, s26, 0xffff
    buffer_load_dwordx4 v[112:115], v3, s[8:11], s26 offen offset:0 sc1
    s_mov_b64 exec, s[44:45]
    buffer_load_dwordx4 v[80:83], v4, s[8:11], s26 offen offset:1024 sc1
    buffer_load_dwordx4 v[84:87], v4, s[8:11], s26 offen offset:1536 sc1
    s_mov_b64 exec, -1
    s_waitcnt vmcnt(0)
    v_max3_u32 v9, v112, v80, v84
    v_cmp_eq_u32 vcc, -1, v9
    s_nop 0
    s_cbranch_vccnz aa_fail0
    s_branch aa_ok0
aa_fail1:
    s_cmp_lg_u32 s46, 0
    s_cbranch_scc1 aa_ok1
    s_add_u32 s47, s47, 1
    s_cmp_ge_u32 s47, 0xf4240
    s_cselect_b32 s46, 1, 0
    s_sleep 1
    s_add_u32 s26, s57, 0x0
    s_and_b32 s26, s26, 0xffff
    buffer_load_dwordx4 v[116:119], v3, s[8:11], s26 offen offset:2048 sc1
    s_mov_b64 exec, s[44:45]
    buffer_load_dwordx4 v[88:91], v4, s[8:11], s26 offen offset:3072 sc1
    buffer_load_dwordx4 v[92:95], v4, s[8:11], s26 offen offset:3584 sc1
    s_mov_b64 exec, -1
    s_waitcnt vmcnt(0)
    v_max3_u32 v9, v116, v88, v92
    v_cmp_eq_u32 vcc, -1, v9
    s_nop 0
    s_cbranch_vccnz aa_fail1
    s_branch aa_ok1
aa_fail2:
    s_cmp_lg_u32 s46, 0
    s_cbranch_scc1 aa_ok2
    s_add_u32 s47, s47, 1
    s_cmp_ge_u32 s47, 0xf4240
    s_cselect_b32 s46, 1, 0
    s_sleep 1
    s_add_u32 s26, s57, 0x1000
    s_and_b32 s26, s26, 0xffff
    buffer_load_dwordx4 v[120:123], v3, s[8:11], s26 offen offset:0 sc1
    s_mov_b64 exec, s[44:45]
    buffer_load_dwordx4 v[96:99], v4, s[8:11], s26 offen offset:1024 sc1
    buffer_load_dwordx4 v[100:103], v4, s[8:11], s26 offen offset:1536 sc1
    s_mov_b64 exec, -1
    s_waitcnt vmcnt(0)
    v_max3_u32 v9, v120, v96, v100
    v_cmp_eq_u32 vcc, -1, v9
    s_nop 0
    s_cbranch_vccnz aa_fail2
    s_branch aa_ok2
aa_fail3:
    s_cmp_lg_u32 s46, 0
    s_cbranch_scc1 aa_ok3
    s_add_u32 s47, s47, 1
    s_cmp_ge_u32 s47, 0xf4240
    s_cselect_b32 s46, 1, 0
    s_sleep 1
    s_add_u32 s26, s57, 0x1000
    s_and_b32 s26, s26, 0xffff
    buffer_load_dwordx4 v[124:127], v3, s[8:11], s26 offen offset:2048 sc1
    s_mov_b64 exec, s[44:45]
    buffer_load_dwordx4 v[104:107], v4, s[8:11], s26 offen offset:3072 sc1
    buffer_load_dwordx4 v[108:111], v4, s[8:11], s26 offen offset:3584 sc1
    s_mov_b64 exec, -1
    s_waitcnt vmcnt(0)
    v_max3_u32 v9, v124, v104, v108
    v_cmp_eq_u32 vcc, -1, v9
    s_nop 0
    s_cbranch_vccnz aa_fail3
    s_branch aa_ok3
aa_fail4:
    s_cmp_lg_u32 s46, 0
    s_cbranch_scc1 aa_ok4
    s_add_u32 s47, s47, 1
    s_cmp_ge_u32 s47, 0xf4240
    s_cselect_b32 s46, 1, 0
    s_sleep 1
    s_add_u32 s26, s57, 0x2000
    s_and_b32 s26, s26, 0xffff
    buffer_load_dwordx4 v[112:115], v3, s[8:11], s26 offen offset:0 sc1
    s_mov_b64 exec, s[44:45]
    buffer_load_dwordx4 v[80:83], v4, s[8:11], s26 offen offset:1024 sc1
    buffer_load_dwordx4 v[84:87], v4, s[8:11], s26 offen offset:1536 sc1
    s_mov_b64 exec, -1
    s_waitcnt vmcnt(0)
    v_max3_u32 v9, v112, v80, v84
    v_cmp_eq_u32 vcc, -1, v9
    s_nop 0
    s_cbranch_vccnz aa_fail4
    s_branch aa_ok4
aa_fail5:
    s_cmp_lg_u32 s46, 0
    s_cbranch_scc1 aa_ok5
    s_add_u32 s47, s47, 1
    s_cmp_ge_u32 s47, 0xf4240
    s_cselect_b32 s46, 1, 0
    s_sleep 1
    s_add_u32 s26, s57, 0x2000
    s_and_b32 s26, s26, 0xffff
    buffer_load_dwordx4 v[116:119], v3, s[8:11], s26 offen offset:2048 sc1
    s_mov_b64 exec, s[44:45]
    buffer_load_dwordx4 v[88:91], v4, s[8:11], s26 offen offset:3072 sc1
    buffer_load_dwordx4 v[92:95], v4, s[8:11], s26 offen offset:3584 sc1
    s_mov_b64 exec, -1
    s_waitcnt vmcnt(0)
    v_max3_u32 v9, v116, v88, v92
    v_cmp_eq_u32 vcc, -1, v9
    s_nop 0
    s_cbranch_vccnz aa_fail5
    s_branch aa_ok5
aa_fail6:
    s_cmp_lg_u32 s46, 0
    s_cbranch_scc1 aa_ok6
    s_add_u32 s47, s47, 1
    s_cmp_ge_u32 s47, 0xf4240
    s_cselect_b32 s46, 1, 0
    s_sleep 1
    s_add_u32 s26, s57, 0x3000
    s_and_b32 s26, s26, 0xffff
    buffer_load_dwordx4 v[120:123], v3, s[8:11], s26 offen offset:0 sc1
    s_mov_b64 exec, s[44:45]
    buffer_load_dwordx4 v[96:99], v4, s[8:11], s26 offen offset:1024 sc1
    buffer_load_dwordx4 v[100:103], v4, s[8:11], s26 offen offset:1536 sc1
    s_mov_b64 exec, -1
    s_waitcnt vmcnt(0)
    v_max3_u32 v9, v120, v96, v100
    v_cmp_eq_u32 vcc, -1, v9
    s_nop 0
    s_cbranch_vccnz aa_fail6
    s_branch aa_ok6
aa_fail7:
    s_cmp_lg_u32 s46, 0
    s_cbranch_scc1 aa_ok7
    s_add_u32 s47, s47, 1
    s_cmp_ge_u32 s47, 0xf4240
    s_cselect_b32 s46, 1, 0
    s_sleep 1
    s_add_u32 s26, s57, 0x3000
    s_and_b32 s26, s26, 0xffff
    buffer_load_dwordx4 v[124:127], v3, s[8:11], s26 offen offset:2048 sc1
    s_mov_b64 exec, s[44:45]
    buffer_load_dwordx4 v[104:107], v4, s[8:11], s26 offen offset:3072 sc1
    buffer_load_dwordx4 v[108:111], v4, s[8:11], s26 offen offset:3584 sc1
    s_mov_b64 exec, -1
    s_waitcnt vmcnt(0)
    v_max3_u32 v9, v124, v104, v108
    v_cmp_eq_u32 vcc, -1, v9
    s_nop 0
    s_cbranch_vccnz aa_fail7
    s_branch aa_ok7
aa_xtf:
    s_cmp_lg_u32 s46, 0
    s_cbranch_scc1 aa_xto
    s_add_u32 s47, s47, 1
    s_cmp_ge_u32 s47, 0xf4240
    s_cselect_b32 s46, 1, 0
    s_sleep 6
    s_lshl_b32 s26, s25, 10
    s_add_u32 s26, s26, 0x40000
    buffer_load_dwordx4 v[240:243], v1, s[8:11], s26 offen sc1
    v_and_b32 v6, 7, v2
    v_lshlrev_b32 v6, 2, v6
    s_lshl_b32 s26, s20, 5
    s_add_u32 s26, s26, 0x40000
    buffer_load_dword v248, v6, s[8:11], s26 offen sc1
    s_waitcnt vmcnt(0)
    s_branch aa_xtc
aa_fail8:
    s_cmp_lg_u32 s46, 0
    s_cbranch_scc1 aa_ok8
    s_add_u32 s47, s47, 1
    s_cmp_ge_u32 s47, 0xf4240
    s_cselect_b32 s46, 1, 0
    s_sleep 1
    s_add_u32 s26, s57, 0x4000
    s_and_b32 s26, s26, 0xffff
    buffer_load_dwordx4 v[112:115], v3, s[8:11], s26 offen offset:0 sc1
    s_mov_b64 exec, s[44:45]
    buffer_load_dwordx4 v[80:83], v4, s[8:11], s26 offen offset:1024 sc1
    buffer_load_dwordx4 v[84:87], v4, s[8:11], s26 offen offset:1536 sc1
    s_mov_b64 exec, -1
    s_waitcnt vmcnt(0)
    v_max3_u32 v9, v112, v80, v84
    v_cmp_eq_u32 vcc, -1, v9
    s_nop 0
    s_cbranch_vccnz aa_fail8
    s_branch aa_ok8
ps_5:
    buffer_store_dwordx4 v[244:247], v14, s[8:11], s33 offen sc1
    s_nop 1
    s_branch ps_6
ps_7:
    buffer_store_dwordx4 v[244:247], v1, s[8:11], s33 offen sc1
    s_nop 1
    s_branch ps_8
aa_fail9:
    s_cmp_lg_u32 s46, 0
    s_cbranch_scc1 aa_ok9
    s_add_u32 s47, s47, 1
    s_cmp_ge_u32 s47, 0xf4240
    s_cselect_b32 s46, 1, 0
    s_sleep 1
    s_add_u32 s26, s57, 0x4000
    s_and_b32 s26, s26, 0xffff
    buffer_load_dwordx4 v[116:119], v3, s[8:11], s26 offen offset:2048 sc1
    s_mov_b64 exec, s[44:45]
    buffer_load_dwordx4 v[88:91], v4, s[8:11], s26 offen offset:3072 sc1
    buffer_load_dwordx4 v[92:95], v4, s[8:11], s26 offen offset:3584 sc1
    s_mov_b64 exec, -1
    s_waitcnt vmcnt(0)
    v_max3_u32 v9, v116, v88, v92
    v_cmp_eq_u32 vcc, -1, v9
    s_nop 0
    s_cbranch_vccnz aa_fail9
    s_branch aa_ok9
ps_9:
    buffer_store_dwordx4 v[244:247], v14, s[8:11], s33 offen sc1
    s_nop 1
    s_branch ps_10
aa_fail10:
    s_cmp_lg_u32 s46, 0
    s_cbranch_scc1 aa_ok10
    s_add_u32 s47, s47, 1
    s_cmp_ge_u32 s47, 0xf4240
    s_cselect_b32 s46, 1, 0
    s_sleep 1
    s_add_u32 s26, s57, 0x5000
    s_and_b32 s26, s26, 0xffff
    buffer_load_dwordx4 v[120:123], v3, s[8:11], s26 offen offset:0 sc1
    s_mov_b64 exec, s[44:45]
    buffer_load_dwordx4 v[96:99], v4, s[8:11], s26 offen offset:1024 sc1
    buffer_load_dwordx4 v[100:103], v4, s[8:11], s26 offen offset:1536 sc1
    s_mov_b64 exec, -1
    s_waitcnt vmcnt(0)
    v_max3_u32 v9, v120, v96, v100
    v_cmp_eq_u32 vcc, -1, v9
    s_nop 0
    s_cbranch_vccnz aa_fail10
    s_branch aa_ok10
ps_11:
    buffer_store_dwordx4 v[244:247], v1, s[8:11], s33 offen sc1
    s_nop 1
    s_branch ps_12
pw_13f:
    s_cmp_lg_u32 s46, 0
    s_cbranch_scc1 pw_13o
    s_add_u32 s47, s47, 1
    s_cmp_ge_u32 s47, 0xf4240
    s_cselect_b32 s46, 1, 0
    ds_read_b32 v221, v209
    ds_read_b32 v56, v8 offset:2048
    ds_read_b128 v[48:51], v10
    ds_read_b128 v[52:55], v10 offset:1024
    s_waitcnt lgkmcnt(0)
    s_branch pw_13
ps_14:
    buffer_store_dwordx4 v[216:219], v14, s[8:11], s26 offen sc1
    s_nop 1
    s_branch ps_15
aa_fb:
    ds_read_b128 v[48:51], v210
    s_waitcnt vmcnt(0) lgkmcnt(0)
    s_mov_b32 s29, 0
    s_mov_b32 s30, 63
    v_mov_b32 v6, 0xff61b1e6
    v_mov_b32 v40, v15
    v_mov_b32 v41, v15
    v_mov_b32 v42, v15
    v_mov_b32 v43, v15
    v_mov_b32 v44, v15
    v_mov_b32 v45, v15
    v_mov_b32 v46, v15
    v_mov_b32 v47, v15
    v_mov_b32 v64, 0
    v_mov_b32 v65, 0
    v_mov_b32 v66, 0
    v_mov_b32 v67, 0
    v_mov_b32 v68, 0
    v_mov_b32 v69, 0
    v_mov_b32 v70, 0
    v_mov_b32 v71, 0
    v_mov_b32 v72, 0
    v_mov_b32 v73, 0
    v_mov_b32 v74, 0
    v_mov_b32 v75, 0
    v_mov_b32 v76, 0
    v_mov_b32 v77, 0
    v_mov_b32 v78, 0
    v_mov_b32 v79, 0
    s_mov_b32 s26, s29
aa_fb1:
    s_lshl_b32 s27, s26, 11
    s_add_u32 s27, s27, s38
    buffer_load_dwordx4 v[36:39], v1, s[8:11], s27 offen sc1
    s_waitcnt vmcnt(0)
    v_mfma_f32_32x32x16_bf16 v[16:31], v[36:39], v[48:51], 0
    s_nop 11
    v_max3_f32 v6, v16, v17, v6
    v_max3_f32 v6, v18, v19, v6
    v_max3_f32 v6, v20, v21, v6
    v_max3_f32 v6, v22, v23, v6
    v_max3_f32 v6, v24, v25, v6
    v_max3_f32 v6, v26, v27, v6
    v_max3_f32 v6, v28, v29, v6
    v_max3_f32 v6, v30, v31, v6
    s_add_u32 s26, s26, 1
    s_cmp_le_u32 s26, s30
    s_cbranch_scc1 aa_fb1
    v_mov_b32 v8, v6
    s_nop 1
    v_permlane32_swap_b32 v6, v8
    v_max_f32 v6, v6, v8
    s_mov_b32 s26, s29
aa_fb2:
    s_lshl_b32 s27, s26, 11
    s_add_u32 s27, s27, s38
    s_nop 7
    buffer_load_dwordx4 v[36:39], v1, s[8:11], s27 offen sc1
    s_mov_b64 exec, s[44:45]
    buffer_load_dwordx4 v[40:43], v13, s[8:11], s27 offen offset:1024 sc1
    buffer_load_dwordx4 v[44:47], v13, s[8:11], s27 offen offset:1536 sc1
    s_mov_b64 exec, -1
    s_waitcnt vmcnt(0)
    v_mfma_f32_32x32x16_bf16 v[16:31], v[36:39], v[48:51], 0
    s_nop 11
    v_sub_f32 v16, v16, v6
    v_sub_f32 v17, v17, v6
    v_sub_f32 v18, v18, v6
    v_sub_f32 v19, v19, v6
    v_sub_f32 v20, v20, v6
    v_sub_f32 v21, v21, v6
    v_sub_f32 v22, v22, v6
    v_sub_f32 v23, v23, v6
    v_sub_f32 v24, v24, v6
    v_sub_f32 v25, v25, v6
    v_sub_f32 v26, v26, v6
    v_sub_f32 v27, v27, v6
    v_sub_f32 v28, v28, v6
    v_sub_f32 v29, v29, v6
    v_sub_f32 v30, v30, v6
    v_sub_f32 v31, v31, v6
    v_exp_f32 v16, v16
    v_exp_f32 v17, v17
    v_exp_f32 v18, v18
    v_exp_f32 v19, v19
    v_exp_f32 v20, v20
    v_exp_f32 v21, v21
    v_exp_f32 v22, v22
    v_exp_f32 v23, v23
    v_exp_f32 v24, v24
    v_exp_f32 v25, v25
    v_exp_f32 v26, v26
    v_exp_f32 v27, v27
    v_exp_f32 v28, v28
    v_exp_f32 v29, v29
    v_exp_f32 v30, v30
    v_exp_f32 v31, v31
    v_smfmac_f32_32x32x32_bf16 v[64:79], v[40:43], v[16:23], v12
    s_nop 0
    v_smfmac_f32_32x32x32_bf16 v[64:79], v[44:47], v[24:31], v12
    s_add_u32 s26, s26, 1
    s_cmp_le_u32 s26, s30
    s_cbranch_scc1 aa_fb2
    s_nop 13
    v_rcp_f32 v6, v72
    s_branch aa_norm
fl_fail:
    s_cmp_lg_u32 s46, 0
    s_cbranch_scc1 fl_ok
    s_add_u32 s47, s47, 1
    s_cmp_ge_u32 s47, 0xf4240
    s_cselect_b32 s46, 1, 0
    s_sleep 4
    v_bfe_u32 v244, v2, 3, 2
    v_add_u32 v244, 1, v244
    v_sub_u32 v244, s20, v244
    v_lshlrev_b32 v244, 9, v244
    v_lshlrev_b32 v246, 2, v2
    v_and_b32 v245, 28, v246
    s_lshl_b32 s26, s21, 5
    v_add3_u32 v244, v244, v245, s26
    v_and_b32 v244, 0x7fffffff, v244
    s_lshl_b32 s26, s25, 8
    s_add_u32 s26, s26, 0x42000
    s_cmp_eq_u32 s22, 7
    s_cselect_b32 s26, s26, 0x40000000
    s_lshl_b32 s27, s20, 9
    s_add_u32 s27, s27, s26
    buffer_load_dword v212, v244, s[8:11], s26 offen sc1
    buffer_load_dword v213, v246, s[8:11], s27 offen sc1
    s_waitcnt vmcnt(0)
    s_branch fl_chk
pa_f0:
    s_call_b64 s[98:99], act_repoll
    s_branch pa_o0
pa_f1:
    s_call_b64 s[98:99], act_repoll
    s_branch pa_o1
pa_f2:
    s_call_b64 s[98:99], act_repoll
    s_branch pa_o2
pa_f3:
    s_call_b64 s[98:99], act_repoll
    s_branch pa_o3
pa_f4:
    s_call_b64 s[98:99], act_repoll
    s_branch pa_o4
pa_f5:
    s_call_b64 s[98:99], act_repoll
    s_branch pa_o5
pa_f6:
    s_call_b64 s[98:99], act_repoll
    s_branch pa_o6
pa_f7:
    s_call_b64 s[98:99], act_repoll
    s_branch pa_o7
pw_16f:
    s_cmp_lg_u32 s46, 0
    s_cbranch_scc1 pw_16o
    s_add_u32 s47, s47, 1
    s_cmp_ge_u32 s47, 0xf4240
    s_cselect_b32 s46, 1, 0
    ds_read_b32 v221, v209
    ds_read_b128 v[64:67], v11
    ds_read_b128 v[68:71], v11 offset:1024
    s_waitcnt lgkmcnt(0)
    s_branch pw_16
ps_17:
    buffer_store_dwordx4 v[236:239], v1, s[8:11], s26 offen sc1
    s_nop 1
    s_branch ps_18
qb_f0:
    s_call_b64 s[98:99], act_repoll
    s_branch qb_o0
qb_f1:
    s_call_b64 s[98:99], act_repoll
    s_branch qb_o1
qb_f2:
    s_call_b64 s[98:99], act_repoll
    s_branch qb_o2
qb_f3:
    s_call_b64 s[98:99], act_repoll
    s_branch qb_o3
qb_f4:
    s_call_b64 s[98:99], act_repoll
    s_branch qb_o4
qb_f5:
    s_call_b64 s[98:99], act_repoll
    s_branch qb_o5
qb_f6:
    s_call_b64 s[98:99], act_repoll
    s_branch qb_o6
qb_f7:
    s_call_b64 s[98:99], act_repoll
    s_branch qb_o7
pw_19f:
    s_cmp_lg_u32 s46, 0
    s_cbranch_scc1 pw_19o
    s_add_u32 s47, s47, 1
    s_cmp_ge_u32 s47, 0xf4240
    s_cselect_b32 s46, 1, 0
    ds_read_b32 v221, v209
    ds_read_b128 v[244:247], v227
    ds_read_b128 v[248:251], v10
    ds_read_b128 v[252:255], v10 offset:1024
    ds_read_b128 v[144:147], v228 offset:0
    ds_read_b128 v[148:151], v228 offset:16
    ds_read_b128 v[152:155], v228 offset:32
    ds_read_b128 v[156:159], v228 offset:48
    s_waitcnt lgkmcnt(0)
    s_branch pw_19
pw_20f:
    s_cmp_lg_u32 s46, 0
    s_cbranch_scc1 pw_20o
    s_add_u32 s47, s47, 1
    s_cmp_ge_u32 s47, 0xf4240
    s_cselect_b32 s46, 1, 0
    ds_read_b32 v221, v209
    ds_read_b128 v[176:179], v11
    ds_read_b128 v[180:183], v11 offset:1024
    s_waitcnt lgkmcnt(0)
    s_branch pw_20
pw_21f:
    s_cmp_lg_u32 s46, 0
    s_cbranch_scc1 pw_21o
    s_add_u32 s47, s47, 1
    s_cmp_ge_u32 s47, 0xf4240
    s_cselect_b32 s46, 1, 0
    ds_read_b32 v221, v209
    s_waitcnt lgkmcnt(0)
    s_branch pw_21
pw_22f:
    s_cmp_lg_u32 s46, 0
    s_cbranch_scc1 pw_22o
    s_add_u32 s47, s47, 1
    s_cmp_ge_u32 s47, 0xf4240
    s_cselect_b32 s46, 1, 0
    ds_read_b32 v221, v209
    ds_read_b128 v[16:19], v10
    ds_read_b128 v[20:23], v10 offset:1024
    ds_read_b128 v[24:27], v229 offset:1024
    ds_read_b128 v[28:31], v229 offset:1088
    s_waitcnt lgkmcnt(0)
    s_branch pw_22
ab_fail1:
    s_call_b64 s[98:99], b_repoll
    s_branch ab_ok1
ab_fail2:
    s_call_b64 s[98:99], b_repoll
    s_branch ab_ok2
ab_fail3:
    s_call_b64 s[98:99], b_repoll
    s_branch ab_ok3
ab_fail4:
    s_call_b64 s[98:99], b_repoll
    s_branch ab_ok4
ab_fail5:
    s_call_b64 s[98:99], b_repoll
    s_branch ab_ok5
ab_fail6:
    s_call_b64 s[98:99], b_repoll
    s_branch ab_ok6
pw_23f:
    s_cmp_lg_u32 s46, 0
    s_cbranch_scc1 pw_23o
    s_add_u32 s47, s47, 1
    s_cmp_ge_u32 s47, 0xf4240
    s_cselect_b32 s46, 1, 0
    ds_read_b32 v221, v209
    ds_read_b32 v56, v8 offset:2048
    ds_read_b128 v[48:51], v11
    ds_read_b128 v[52:55], v11 offset:1024
    s_waitcnt lgkmcnt(0)
    s_branch pw_23
ps_24:
    buffer_store_dwordx4 v[216:219], v14, s[8:11], s26 offen sc1
    s_nop 1
    s_branch ps_25
ab_fb:
    s_waitcnt vmcnt(0) lgkmcnt(0)
    s_lshl_b32 s30, s20, 1
    s_add_u32 s30, s30, s24
    s_sub_i32 s29, s30, 8
    s_max_i32 s29, s29, 0
    v_and_b32 v7, 31, v2
    v_lshrrev_b32 v8, 5, v2
    v_lshlrev_b32 v8, 2, v8
    v_sub_u32 v7, v7, v8
    v_mov_b32 v32, 0xceabfb8f
    v_mov_b32 v6, 0xff61b1e6
    v_mov_b32 v80, v15
    v_mov_b32 v81, v15
    v_mov_b32 v82, v15
    v_mov_b32 v83, v15
    v_mov_b32 v84, v15
    v_mov_b32 v85, v15
    v_mov_b32 v86, v15
    v_mov_b32 v87, v15
    v_mov_b32 v64, 0
    v_mov_b32 v65, 0
    v_mov_b32 v66, 0
    v_mov_b32 v67, 0
    v_mov_b32 v68, 0
    v_mov_b32 v69, 0
    v_mov_b32 v70, 0
    v_mov_b32 v71, 0
    v_mov_b32 v72, 0
    v_mov_b32 v73, 0
    v_mov_b32 v74, 0
    v_mov_b32 v75, 0
    v_mov_b32 v76, 0
    v_mov_b32 v77, 0
    v_mov_b32 v78, 0
    v_mov_b32 v79, 0
    s_mov_b32 s26, s29
ab_fb1:
    s_lshr_b32 s27, s26, 1
    s_mul_i32 s27, s27, 0x60000
    s_and_b32 s28, s26, 1
    s_lshl_b32 s28, s28, 11
    s_add_u32 s27, s27, s28
    s_add_u32 s27, s27, s58
    buffer_load_dwordx4 v[120:123], v1, s[8:11], s27 offen sc1
    s_waitcnt vmcnt(0)
    v_mfma_f32_32x32x16_bf16 v[16:31], v[120:123], v[148:151], 0
    s_sub_u32 s31, s30, s26
    s_lshl_b32 s31, s31, 5
    v_add_u32 v8, s31, v7
    v_subrev_u32 v9, 0, v8
    v_cmp_gt_u32 vcc, 0x100, v9
    s_nop 6
    v_cndmask_b32 v16, v32, v16, vcc
    v_subrev_u32 v9, 1, v8
    v_cmp_gt_u32 vcc, 0x100, v9
    s_nop 1
    v_cndmask_b32 v17, v32, v17, vcc
    v_subrev_u32 v9, 2, v8
    v_cmp_gt_u32 vcc, 0x100, v9
    s_nop 1
    v_cndmask_b32 v18, v32, v18, vcc
    v_subrev_u32 v9, 3, v8
    v_cmp_gt_u32 vcc, 0x100, v9
    s_nop 1
    v_cndmask_b32 v19, v32, v19, vcc
    v_subrev_u32 v9, 8, v8
    v_cmp_gt_u32 vcc, 0x100, v9
    s_nop 1
    v_cndmask_b32 v20, v32, v20, vcc
    v_subrev_u32 v9, 9, v8
    v_cmp_gt_u32 vcc, 0x100, v9
    s_nop 1
    v_cndmask_b32 v21, v32, v21, vcc
    v_subrev_u32 v9, 10, v8
    v_cmp_gt_u32 vcc, 0x100, v9
    s_nop 1
    v_cndmask_b32 v22, v32, v22, vcc
    v_subrev_u32 v9, 11, v8
    v_cmp_gt_u32 vcc, 0x100, v9
    s_nop 1
    v_cndmask_b32 v23, v32, v23, vcc
    v_subrev_u32 v9, 16, v8
    v_cmp_gt_u32 vcc, 0x100, v9
    s_nop 1
    v_cndmask_b32 v24, v32, v24, vcc
    v_subrev_u32 v9, 17, v8
    v_cmp_gt_u32 vcc, 0x100, v9
    s_nop 1
    v_cndmask_b32 v25, v32, v25, vcc
    v_subrev_u32 v9, 18, v8
    v_cmp_gt_u32 vcc, 0x100, v9
    s_nop 1
    v_cndmask_b32 v26, v32, v26, vcc
    v_subrev_u32 v9, 19, v8
    v_cmp_gt_u32 vcc, 0x100, v9
    s_nop 1
    v_cndmask_b32 v27, v32, v27, vcc
    v_subrev_u32 v9, 24, v8
    v_cmp_gt_u32 vcc, 0x100, v9
    s_nop 1
    v_cndmask_b32 v28, v32, v28, vcc
    v_subrev_u32 v9, 25, v8
    v_cmp_gt_u32 vcc, 0x100, v9
    s_nop 1
    v_cndmask_b32 v29, v32, v29, vcc
    v_subrev_u32 v9, 26, v8
    v_cmp_gt_u32 vcc, 0x100, v9
    s_nop 1
    v_cndmask_b32 v30, v32, v30, vcc
    v_subrev_u32 v9, 27, v8
    v_cmp_gt_u32 vcc, 0x100, v9
    s_nop 1
    v_cndmask_b32 v31, v32, v31, vcc
    v_max3_f32 v6, v16, v17, v6
    v_max3_f32 v6, v18, v19, v6
    v_max3_f32 v6, v20, v21, v6
    v_max3_f32 v6, v22, v23, v6
    v_max3_f32 v6, v24, v25, v6
    v_max3_f32 v6, v26, v27, v6
    v_max3_f32 v6, v28, v29, v6
    v_max3_f32 v6, v30, v31, v6
    s_add_u32 s26, s26, 1
    s_cmp_le_u32 s26, s30
    s_cbranch_scc1 ab_fb1
    v_mov_b32 v8, v6
    s_nop 1
    v_permlane32_swap_b32 v6, v8
    v_max_f32 v6, v6, v8
    s_mov_b32 s26, s29
ab_fb2:
    s_lshr_b32 s27, s26, 1
    s_mul_i32 s27, s27, 0x60000
    s_and_b32 s28, s26, 1
    s_lshl_b32 s28, s28, 11
    s_add_u32 s27, s27, s28
    s_add_u32 s27, s27, s58
    s_nop 7
    buffer_load_dwordx4 v[120:123], v1, s[8:11], s27 offen sc1
    s_mov_b64 exec, s[44:45]
    buffer_load_dwordx4 v[80:83], v13, s[8:11], s27 offen offset:1024 sc1
    buffer_load_dwordx4 v[84:87], v13, s[8:11], s27 offen offset:1536 sc1
    s_mov_b64 exec, -1
    s_waitcnt vmcnt(0)
    v_mfma_f32_32x32x16_bf16 v[16:31], v[120:123], v[148:151], 0
    s_sub_u32 s31, s30, s26
    s_lshl_b32 s31, s31, 5
    v_add_u32 v8, s31, v7
    v_subrev_u32 v9, 0, v8
    v_cmp_gt_u32 vcc, 0x100, v9
    s_nop 6
    v_cndmask_b32 v16, v32, v16, vcc
    v_subrev_u32 v9, 1, v8
    v_cmp_gt_u32 vcc, 0x100, v9
    s_nop 1
    v_cndmask_b32 v17, v32, v17, vcc
    v_subrev_u32 v9, 2, v8
    v_cmp_gt_u32 vcc, 0x100, v9
    s_nop 1
    v_cndmask_b32 v18, v32, v18, vcc
    v_subrev_u32 v9, 3, v8
    v_cmp_gt_u32 vcc, 0x100, v9
    s_nop 1
    v_cndmask_b32 v19, v32, v19, vcc
    v_subrev_u32 v9, 8, v8
    v_cmp_gt_u32 vcc, 0x100, v9
    s_nop 1
    v_cndmask_b32 v20, v32, v20, vcc
    v_subrev_u32 v9, 9, v8
    v_cmp_gt_u32 vcc, 0x100, v9
    s_nop 1
    v_cndmask_b32 v21, v32, v21, vcc
    v_subrev_u32 v9, 10, v8
    v_cmp_gt_u32 vcc, 0x100, v9
    s_nop 1
    v_cndmask_b32 v22, v32, v22, vcc
    v_subrev_u32 v9, 11, v8
    v_cmp_gt_u32 vcc, 0x100, v9
    s_nop 1
    v_cndmask_b32 v23, v32, v23, vcc
    v_subrev_u32 v9, 16, v8
    v_cmp_gt_u32 vcc, 0x100, v9
    s_nop 1
    v_cndmask_b32 v24, v32, v24, vcc
    v_subrev_u32 v9, 17, v8
    v_cmp_gt_u32 vcc, 0x100, v9
    s_nop 1
    v_cndmask_b32 v25, v32, v25, vcc
    v_subrev_u32 v9, 18, v8
    v_cmp_gt_u32 vcc, 0x100, v9
    s_nop 1
    v_cndmask_b32 v26, v32, v26, vcc
    v_subrev_u32 v9, 19, v8
    v_cmp_gt_u32 vcc, 0x100, v9
    s_nop 1
    v_cndmask_b32 v27, v32, v27, vcc
    v_subrev_u32 v9, 24, v8
    v_cmp_gt_u32 vcc, 0x100, v9
    s_nop 1
    v_cndmask_b32 v28, v32, v28, vcc
    v_subrev_u32 v9, 25, v8
    v_cmp_gt_u32 vcc, 0x100, v9
    s_nop 1
    v_cndmask_b32 v29, v32, v29, vcc
    v_subrev_u32 v9, 26, v8
    v_cmp_gt_u32 vcc, 0x100, v9
    s_nop 1
    v_cndmask_b32 v30, v32, v30, vcc
    v_subrev_u32 v9, 27, v8
    v_cmp_gt_u32 vcc, 0x100, v9
    s_nop 1
    v_cndmask_b32 v31, v32, v31, vcc
    v_sub_f32 v16, v16, v6
    v_sub_f32 v17, v17, v6
    v_sub_f32 v18, v18, v6
    v_sub_f32 v19, v19, v6
    v_sub_f32 v20, v20, v6
    v_sub_f32 v21, v21, v6
    v_sub_f32 v22, v22, v6
    v_sub_f32 v23, v23, v6
    v_sub_f32 v24, v24, v6
    v_sub_f32 v25, v25, v6
    v_sub_f32 v26, v26, v6
    v_sub_f32 v27, v27, v6
    v_sub_f32 v28, v28, v6
    v_sub_f32 v29, v29, v6
    v_sub_f32 v30, v30, v6
    v_sub_f32 v31, v31, v6
    v_exp_f32 v16, v16
    v_exp_f32 v17, v17
    v_exp_f32 v18, v18
    v_exp_f32 v19, v19
    v_exp_f32 v20, v20
    v_exp_f32 v21, v21
    v_exp_f32 v22, v22
    v_exp_f32 v23, v23
    v_exp_f32 v24, v24
    v_exp_f32 v25, v25
    v_exp_f32 v26, v26
    v_exp_f32 v27, v27
    v_exp_f32 v28, v28
    v_exp_f32 v29, v29
    v_exp_f32 v30, v30
    v_exp_f32 v31, v31
    v_smfmac_f32_32x32x32_bf16 v[64:79], v[80:83], v[16:23], v12
    s_nop 0
    v_smfmac_f32_32x32x32_bf16 v[64:79], v[84:87], v[24:31], v12
    s_add_u32 s26, s26, 1
    s_cmp_le_u32 s26, s30
    s_cbranch_scc1 ab_fb2
    s_nop 13
    v_rcp_f32 v6, v72
    s_branch ab_norm
pb_f0:
    s_call_b64 s[98:99], act_repoll
    s_branch pb_o0
pb_f1:
    s_call_b64 s[98:99], act_repoll
    s_branch pb_o1
pb_f2:
    s_call_b64 s[98:99], act_repoll
    s_branch pb_o2
pb_f3:
    s_call_b64 s[98:99], act_repoll
    s_branch pb_o3
pb_f4:
    s_call_b64 s[98:99], act_repoll
    s_branch pb_o4
pb_f5:
    s_call_b64 s[98:99], act_repoll
    s_branch pb_o5
pb_f6:
    s_call_b64 s[98:99], act_repoll
    s_branch pb_o6
pb_f7:
    s_call_b64 s[98:99], act_repoll
    s_branch pb_o7
pw_26f:
    s_cmp_lg_u32 s46, 0
    s_cbranch_scc1 pw_26o
    s_add_u32 s47, s47, 1
    s_cmp_ge_u32 s47, 0xf4240
    s_cselect_b32 s46, 1, 0
    ds_read_b32 v221, v209
    ds_read_b128 v[64:67], v10
    ds_read_b128 v[68:71], v10 offset:1024
    s_waitcnt lgkmcnt(0)
    s_branch pw_26
ps_27:
    buffer_store_dwordx4 v[236:239], v1, s[8:11], s26 offen sc1
    s_nop 1
    s_branch ps_28
code_end:
    s_endpgm
.section .rodata,"a"
.p2align 6
.amdhsa_kernel interleave_layers__grouped_kv_mqa__sliding_block__prompt_kernel
  .amdhsa_next_free_vgpr 256
  .amdhsa_next_free_sgpr 102
  .amdhsa_accum_offset 256
  .amdhsa_group_segment_fixed_size 0
  .amdhsa_kernarg_size 88
  .amdhsa_user_sgpr_count 2
  .amdhsa_user_sgpr_kernarg_segment_ptr 1
  .amdhsa_system_sgpr_workgroup_id_x 1
.end_amdhsa_kernel
```
